```python
import torch

def _softmax(x, axis=-1):
    return torch.softmax(x, dim=axis)
def _gelu(x):
    return torch.nn.functional.gelu(x, approximate="tanh")
def _silu(x):
    return torch.nn.functional.silu(x)
def _sigmoid(x):
    return torch.sigmoid(x)
def _layernorm(x, axis=-1, eps=1e-5):
    m = x.mean(dim=axis, keepdim=True)
    v = x.var(dim=axis, keepdim=True, unbiased=False)
    return (x - m) / torch.sqrt(v + eps)
def _scatter_add(tgt, idx, src, axis=0):
    return tgt.clone().index_add_(axis, idx, src)
def _segment_sum(src, seg, n):
    out = torch.zeros((n,) + src.shape[1:], dtype=src.dtype)
    return out.index_add_(0, seg, src)
def _pad(x, pw):
    flat = tuple(v for pair in reversed(pw) for v in pair)
    return torch.nn.functional.pad(x, flat)

kernel_name = 'standalone__gqa_softmax__near_ridge'

def setup_inputs():

    _w = (lambda a: (lambda t: t.to(torch.bfloat16) if t.is_floating_point() else t)(torch.as_tensor(a)))
    B, Hq, Hkv, Sq, Sk, D = 8, 32, 32, 256, 1024, 128
    return {
        "q": _w((lambda *s: torch.randn(*s, dtype=torch.bfloat16) * 0.8)(B, Hq, Sq, D)),
        "k": _w((lambda *s: torch.randn(*s, dtype=torch.bfloat16) * 0.8)(B, Hkv, Sk, D)),
        "v": _w((lambda *s: torch.randn(*s, dtype=torch.bfloat16) * 0.05)(B, Hkv, Sk, D)),
    }

def reference(q, k, v):
    B, Hq, Sq, D = q.shape
    Hkv = k.shape[1]
    rep = Hq // Hkv
    k = (lambda x, n, axis: torch.repeat_interleave(x, n, dim=axis))(k, rep, axis=1)
    v = (lambda x, n, axis: torch.repeat_interleave(x, n, dim=axis))(v, rep, axis=1)
    scale = D ** -0.5
    scores = torch.einsum("bhqd,bhkd->bhqk", q, k) * scale
    p = _softmax(scores, axis=-1)
    return torch.einsum("bhqk,bhkd->bhqd", p, v)
```

```asm
; @launch grid=(256,1,1) block=(256,1,1) lds=149760
.amdgcn_target "amdgcn-amd-amdhsa--gfx950"
.text
.globl standalone__gqa_softmax__near_ridge_kernel
.p2align 8
.type standalone__gqa_softmax__near_ridge_kernel,@function
standalone__gqa_softmax__near_ridge_kernel:
s_load_dwordx4 s[4:7], s[0:1], 0
s_load_dwordx4 s[40:43], s[0:1], 16
s_lshr_b32 s36, s2, 8
s_cbranch_scc1 L_end
s_getpc_b64 s[48:49]
v_lshlrev_b32 v27, 7, v0
v_min_u32 v27, 17408, v27
global_load_dword v192, v27, s[48:49]
v_lshrrev_b32 v26, 6, v0
v_lshlrev_b32 v6, 4, v0
v_readfirstlane_b32 s3, v26
v_lshlrev_b32 v26, 2, v0
v_and_b32 v26, 0xc0, v26
v_xor_b32 v60, v26, v6
s_movk_i32 s38, 3056
v_add_u32 v61, s38, v60
v_add_u32 v62, s38, v61
v_add_u32 v63, s38, v62
s_mul_i32 s27, s3, 4160
s_lshl_b32 s36, s2, 16
s_mov_b32 s10, 65536
s_mov_b32 s11, 0x20000
v_add_u32 v7, s38, v6
v_add_u32 v8, s38, v7
v_add_u32 v9, s38, v8
s_lshl_b32 s37, s2, 18
s_lshl_b32 s14, s10, 2
s_mov_b32 s15, s11
s_add_u32 m0, s27, 83200
s_waitcnt lgkmcnt(0)
s_add_u32 s8, s4, s36
s_addc_u32 s9, s5, 0
buffer_load_dwordx4 v60, s[8:11], 0 offen offset:0 nt lds
buffer_load_dwordx4 v61, s[8:11], 0 offen offset:1040 nt lds
buffer_load_dwordx4 v62, s[8:11], 0 offen offset:2080 nt lds
buffer_load_dwordx4 v63, s[8:11], 0 offen offset:3120 nt lds
s_add_u32 m0, s27, 0
s_add_u32 s12, s6, s37
s_addc_u32 s13, s7, 0
buffer_load_dwordx4 v6, s[12:15], 0 offen offset:0 nt lds
buffer_load_dwordx4 v7, s[12:15], 0 offen offset:1040 nt lds
buffer_load_dwordx4 v8, s[12:15], 0 offen offset:2080 nt lds
buffer_load_dwordx4 v9, s[12:15], 0 offen offset:3120 nt lds
v_and_b32 v1, 63, v0
s_mul_i32 s31, s3, 17408
s_mov_b32 s18, s14
s_mov_b32 s19, s11
s_mov_b32 s22, s10
s_mov_b32 s23, s11
s_mov_b32 s32, 16384
s_mov_b32 s33, 32768
s_mov_b32 s34, 49152
s_add_u32 s16, s40, s37
s_addc_u32 s17, s41, 0
s_add_u32 s20, s42, s36
s_addc_u32 s21, s43, 0
v_bfe_u32 v26, v1, 2, 2
v_lshrrev_b32 v27, 1, v26
v_xor_b32 v27, v26, v27
v_and_b32 v28, 3, v1
v_lshrrev_b32 v29, 4, v1
v_and_b32 v17, 1, v29
v_lshrrev_b32 v19, 1, v29
v_lshl_add_u32 v17, v17, 1, v19
v_lshl_add_u32 v3, v27, 2, v28
v_mul_u32_u24 v3, 1040, v3
v_lshl_add_u32 v3, v17, 6, v3
v_mul_u32_u24 v14, 1040, v28
v_lshl_add_u32 v14, v27, 8, v14
v_xor_b32 v17, v17, v27
v_lshl_add_u32 v14, v17, 6, v14
v_add_u32 v14, s27, v14
v_add_u32 v14, 83200, v14
v_lshl_add_u32 v15, v28, 2, v27
v_mul_u32_u24 v15, 272, v15
v_lshl_add_u32 v15, v19, 7, v15
v_and_b32 v17, 1, v29
v_lshl_add_u32 v15, v17, 3, v15
v_add_u32 v15, s31, v15
v_mul_u32_u24 v16, 272, v29
v_and_b32 v17, 15, v1
v_lshl_add_u32 v16, v17, 4, v16
v_add_u32 v16, s31, v16
v_xor_b32 v19, v29, v19
v_lshl_add_u32 v5, v19, 2, v26
v_mul_u32_u24 v5, 1040, v5
v_lshrrev_b32 v17, 1, v28
v_lshl_add_u32 v5, v17, 7, v5
v_and_b32 v17, 1, v28
v_lshl_add_u32 v5, v17, 3, v5
v_add_u32 v2, 66560, v3
v_add_u32 v4, 66560, v5
s_mov_b32 s24, 0x3e0293ee
s_mov_b32 s25, 0x3e0293ee
s_mov_b32 s26, 0x5d800000
s_mov_b32 s28, 65536
s_mov_b32 s29, 99840
s_mov_b32 s30, 0
s_mov_b32 s35, 33280
s_getreg_b32 s39, hwreg(HW_REG_XCC_ID, 0, 1)
s_cmp_lg_u32 s39, 0
s_mov_b32 s39, 81920
s_cselect_b32 s39, s39, 98304
v_mov_b32 v10, 0
v_mov_b32 v11, 0
v_mov_b32 v12, 0
v_mov_b32 v13, 0
v_mov_b32 v32, 0x3f803f80
v_mov_b32 v33, 0x3f803f80
v_mov_b32 v34, 0x3f803f80
v_mov_b32 v35, 0x3f803f80
s_waitcnt vmcnt(4)
ds_read_b128 v[128:131], v14 offset:0
ds_read_b128 v[132:135], v14 offset:16
ds_read_b128 v[136:139], v14 offset:32
ds_read_b128 v[140:143], v14 offset:48
s_add_u32 m0, s27, 16640
s_nop 0
buffer_load_dwordx4 v6, s[16:19], 0 offen offset:0 nt lds
buffer_load_dwordx4 v7, s[16:19], 0 offen offset:1040 nt lds
buffer_load_dwordx4 v8, s[16:19], 0 offen offset:2080 nt lds
buffer_load_dwordx4 v9, s[16:19], 0 offen offset:3120 nt lds
s_waitcnt lgkmcnt(0)
v_lshlrev_b32 v144, 16, v128
v_and_b32 v145, 0xffff0000, v128
v_lshlrev_b32 v146, 16, v129
v_and_b32 v147, 0xffff0000, v129
v_lshlrev_b32 v148, 16, v130
v_and_b32 v149, 0xffff0000, v130
v_lshlrev_b32 v150, 16, v131
v_and_b32 v151, 0xffff0000, v131
v_lshlrev_b32 v152, 16, v132
v_and_b32 v153, 0xffff0000, v132
v_lshlrev_b32 v154, 16, v133
v_and_b32 v155, 0xffff0000, v133
v_lshlrev_b32 v156, 16, v134
v_and_b32 v157, 0xffff0000, v134
v_lshlrev_b32 v158, 16, v135
v_and_b32 v159, 0xffff0000, v135
v_pk_mul_f32 v[144:145], v[144:145], s[24:25]
v_pk_mul_f32 v[146:147], v[146:147], s[24:25]
v_pk_mul_f32 v[148:149], v[148:149], s[24:25]
v_pk_mul_f32 v[150:151], v[150:151], s[24:25]
v_pk_mul_f32 v[152:153], v[152:153], s[24:25]
v_pk_mul_f32 v[154:155], v[154:155], s[24:25]
v_pk_mul_f32 v[156:157], v[156:157], s[24:25]
v_pk_mul_f32 v[158:159], v[158:159], s[24:25]
v_cvt_pk_bf16_f32 v128, v144, v145
v_cvt_pk_bf16_f32 v129, v146, v147
v_cvt_pk_bf16_f32 v130, v148, v149
v_cvt_pk_bf16_f32 v131, v150, v151
v_cvt_pk_bf16_f32 v132, v152, v153
v_cvt_pk_bf16_f32 v133, v154, v155
v_cvt_pk_bf16_f32 v134, v156, v157
v_cvt_pk_bf16_f32 v135, v158, v159
v_accvgpr_write_b32 a0, v128
v_accvgpr_write_b32 a1, v129
v_accvgpr_write_b32 a2, v130
v_accvgpr_write_b32 a3, v131
v_accvgpr_write_b32 a4, v132
v_accvgpr_write_b32 a5, v133
v_accvgpr_write_b32 a6, v134
v_accvgpr_write_b32 a7, v135
v_lshlrev_b32 v144, 16, v136
v_and_b32 v145, 0xffff0000, v136
v_lshlrev_b32 v146, 16, v137
v_and_b32 v147, 0xffff0000, v137
v_lshlrev_b32 v148, 16, v138
v_and_b32 v149, 0xffff0000, v138
v_lshlrev_b32 v150, 16, v139
v_and_b32 v151, 0xffff0000, v139
v_lshlrev_b32 v152, 16, v140
v_and_b32 v153, 0xffff0000, v140
v_lshlrev_b32 v154, 16, v141
v_and_b32 v155, 0xffff0000, v141
v_lshlrev_b32 v156, 16, v142
v_and_b32 v157, 0xffff0000, v142
v_lshlrev_b32 v158, 16, v143
v_and_b32 v159, 0xffff0000, v143
v_pk_mul_f32 v[144:145], v[144:145], s[24:25]
v_pk_mul_f32 v[146:147], v[146:147], s[24:25]
v_pk_mul_f32 v[148:149], v[148:149], s[24:25]
v_pk_mul_f32 v[150:151], v[150:151], s[24:25]
v_pk_mul_f32 v[152:153], v[152:153], s[24:25]
v_pk_mul_f32 v[154:155], v[154:155], s[24:25]
v_pk_mul_f32 v[156:157], v[156:157], s[24:25]
v_pk_mul_f32 v[158:159], v[158:159], s[24:25]
v_cvt_pk_bf16_f32 v136, v144, v145
v_cvt_pk_bf16_f32 v137, v146, v147
v_cvt_pk_bf16_f32 v138, v148, v149
v_cvt_pk_bf16_f32 v139, v150, v151
v_cvt_pk_bf16_f32 v140, v152, v153
v_cvt_pk_bf16_f32 v141, v154, v155
v_cvt_pk_bf16_f32 v142, v156, v157
v_cvt_pk_bf16_f32 v143, v158, v159
v_accvgpr_write_b32 a8, v136
v_accvgpr_write_b32 a9, v137
v_accvgpr_write_b32 a10, v138
v_accvgpr_write_b32 a11, v139
v_accvgpr_write_b32 a12, v140
v_accvgpr_write_b32 a13, v141
v_accvgpr_write_b32 a14, v142
v_accvgpr_write_b32 a15, v143
s_waitcnt vmcnt(4)
s_barrier
ds_read_b128 a[128:131], v3 offset:0
ds_read_b128 a[132:135], v3 offset:16
ds_read_b128 a[136:139], v3 offset:32
ds_read_b128 a[140:143], v3 offset:48
ds_read_b128 a[144:147], v3 offset:256
ds_read_b128 a[148:151], v3 offset:272
ds_read_b128 a[152:155], v3 offset:288
ds_read_b128 a[156:159], v3 offset:304
ds_read_b128 a[160:163], v3 offset:512
ds_read_b128 a[164:167], v3 offset:528
ds_read_b128 a[168:171], v3 offset:544
ds_read_b128 a[172:175], v3 offset:560
ds_read_b128 a[176:179], v3 offset:768
ds_read_b128 a[180:183], v3 offset:784
ds_read_b128 a[184:187], v3 offset:800
ds_read_b128 a[188:191], v3 offset:816
s_add_u32 m0, s27, 99840
s_nop 0
buffer_load_dwordx4 v60, s[8:11], s32 offen offset:0 nt lds
buffer_load_dwordx4 v61, s[8:11], s32 offen offset:1040 nt lds
buffer_load_dwordx4 v62, s[8:11], s32 offen offset:2080 nt lds
buffer_load_dwordx4 v63, s[8:11], s32 offen offset:3120 nt lds
s_waitcnt lgkmcnt(8)
v_mfma_f32_16x16x32_bf16 v[64:67], a[128:131], a[0:3], 0
v_mfma_f32_16x16x32_bf16 v[64:67], a[132:135], a[4:7], v[64:67]
v_mfma_f32_16x16x32_bf16 v[64:67], a[136:139], a[8:11], v[64:67]
v_mfma_f32_16x16x32_bf16 v[64:67], a[140:143], a[12:15], v[64:67]
v_mfma_f32_16x16x32_bf16 v[68:71], a[144:147], a[0:3], 0
v_mfma_f32_16x16x32_bf16 v[68:71], a[148:151], a[4:7], v[68:71]
v_mfma_f32_16x16x32_bf16 v[68:71], a[152:155], a[8:11], v[68:71]
v_mfma_f32_16x16x32_bf16 v[68:71], a[156:159], a[12:15], v[68:71]
s_waitcnt lgkmcnt(0)
v_mfma_f32_16x16x32_bf16 v[44:47], a[160:163], a[0:3], 0
v_mfma_f32_16x16x32_bf16 v[44:47], a[164:167], a[4:7], v[44:47]
v_mfma_f32_16x16x32_bf16 v[44:47], a[168:171], a[8:11], v[44:47]
v_mfma_f32_16x16x32_bf16 v[44:47], a[172:175], a[12:15], v[44:47]
v_mfma_f32_16x16x32_bf16 v[48:51], a[176:179], a[0:3], 0
v_mfma_f32_16x16x32_bf16 v[48:51], a[180:183], a[4:7], v[48:51]
v_mfma_f32_16x16x32_bf16 v[48:51], a[184:187], a[8:11], v[48:51]
v_mfma_f32_16x16x32_bf16 v[48:51], a[188:191], a[12:15], v[48:51]
v_max3_f32 v26, v64, v65, v66
v_max3_f32 v26, v26, v67, v68
v_max3_f32 v26, v26, v69, v70
s_nop 0
v_max3_f32 v26, v26, v71, v44
v_max3_f32 v26, v26, v45, v46
s_nop 1
v_max3_f32 v26, v26, v47, v48
v_max3_f32 v26, v26, v49, v50
v_max_f32 v26, v26, v51
v_mov_b32 v27, v26
s_nop 1
v_permlane32_swap_b32 v26, v27
v_max_f32 v26, v26, v27
v_mov_b32 v27, v26
s_nop 1
v_permlane16_swap_b32 v26, v27
v_max_f32 v26, v26, v27
v_sub_f32 v96, 0, v26
v_sub_f32 v97, 0, v26
v_sub_f32 v98, 0, v26
v_sub_f32 v99, 0, v26
v_add_f32 v64, v64, v96
v_add_f32 v65, v65, v96
v_add_f32 v66, v66, v96
v_exp_f32 v64, v64
v_add_f32 v67, v67, v96
v_exp_f32 v65, v65
v_add_f32 v68, v68, v96
v_exp_f32 v66, v66
v_add_f32 v69, v69, v96
v_exp_f32 v67, v67
v_cvt_pk_bf16_f32 v64, v64, v65
v_add_f32 v70, v70, v96
v_exp_f32 v68, v68
v_add_f32 v71, v71, v96
v_exp_f32 v69, v69
v_cvt_pk_bf16_f32 v65, v66, v67
v_exp_f32 v70, v70
v_exp_f32 v71, v71
v_cvt_pk_bf16_f32 v66, v68, v69
v_cvt_pk_bf16_f32 v67, v70, v71
v_add_f32 v44, v44, v96
v_add_f32 v45, v45, v96
v_add_f32 v46, v46, v96
v_exp_f32 v44, v44
v_add_f32 v47, v47, v96
v_exp_f32 v45, v45
v_add_f32 v48, v48, v96
v_exp_f32 v46, v46
v_add_f32 v49, v49, v96
v_exp_f32 v47, v47
v_cvt_pk_bf16_f32 v44, v44, v45
v_add_f32 v50, v50, v96
v_exp_f32 v48, v48
v_add_f32 v51, v51, v96
v_exp_f32 v49, v49
v_cvt_pk_bf16_f32 v45, v46, v47
v_exp_f32 v50, v50
v_exp_f32 v51, v51
v_cvt_pk_bf16_f32 v46, v48, v49
v_cvt_pk_bf16_f32 v47, v50, v51
s_waitcnt vmcnt(4)
s_barrier
ds_read_b64_tr_b16 a[192:193], v5 offset:16640
ds_read_b64_tr_b16 a[194:195], v5 offset:16896
ds_read_b64_tr_b16 a[224:225], v5 offset:17152
ds_read_b64_tr_b16 a[226:227], v5 offset:17408
ds_read_b64_tr_b16 a[196:197], v5 offset:16656
ds_read_b64_tr_b16 a[198:199], v5 offset:16912
ds_read_b64_tr_b16 a[228:229], v5 offset:17168
ds_read_b64_tr_b16 a[230:231], v5 offset:17424
ds_read_b64_tr_b16 a[200:201], v5 offset:16672
ds_read_b64_tr_b16 a[202:203], v5 offset:16928
ds_read_b64_tr_b16 a[232:233], v5 offset:17184
ds_read_b64_tr_b16 a[234:235], v5 offset:17440
ds_read_b64_tr_b16 a[204:205], v5 offset:16688
ds_read_b64_tr_b16 a[206:207], v5 offset:16944
ds_read_b64_tr_b16 a[236:237], v5 offset:17200
ds_read_b64_tr_b16 a[238:239], v5 offset:17456
s_add_u32 m0, s27, 116480
s_nop 0
buffer_load_dwordx4 v60, s[8:11], s33 offen offset:0 nt lds
buffer_load_dwordx4 v61, s[8:11], s33 offen offset:1040 nt lds
buffer_load_dwordx4 v62, s[8:11], s33 offen offset:2080 nt lds
buffer_load_dwordx4 v63, s[8:11], s33 offen offset:3120 nt lds
ds_read_b64_tr_b16 a[208:209], v5 offset:16704
ds_read_b64_tr_b16 a[210:211], v5 offset:16960
ds_read_b64_tr_b16 a[240:241], v5 offset:17216
ds_read_b64_tr_b16 a[242:243], v5 offset:17472
ds_read_b64_tr_b16 a[212:213], v5 offset:16720
ds_read_b64_tr_b16 a[214:215], v5 offset:16976
ds_read_b64_tr_b16 a[244:245], v5 offset:17232
ds_read_b64_tr_b16 a[246:247], v5 offset:17488
ds_read_b64_tr_b16 a[216:217], v5 offset:16736
ds_read_b64_tr_b16 a[218:219], v5 offset:16992
ds_read_b64_tr_b16 a[248:249], v5 offset:17248
ds_read_b64_tr_b16 a[250:251], v5 offset:17504
ds_read_b64_tr_b16 a[220:221], v5 offset:16752
ds_read_b64_tr_b16 a[222:223], v5 offset:17008
ds_read_b64_tr_b16 a[252:253], v5 offset:17264
ds_read_b64_tr_b16 a[254:255], v5 offset:17520
s_waitcnt lgkmcnt(0)
v_mfma_f32_16x16x32_bf16 v[128:131], a[192:195], v[64:67], 0
v_mfma_f32_16x16x32_bf16 v[128:131], a[224:227], v[44:47], v[128:131]
v_mfma_f32_16x16x32_bf16 v[132:135], a[196:199], v[64:67], 0
v_mfma_f32_16x16x32_bf16 v[132:135], a[228:231], v[44:47], v[132:135]
v_mfma_f32_16x16x32_bf16 v[136:139], a[200:203], v[64:67], 0
v_mfma_f32_16x16x32_bf16 v[136:139], a[232:235], v[44:47], v[136:139]
v_mfma_f32_16x16x32_bf16 v[140:143], a[204:207], v[64:67], 0
v_mfma_f32_16x16x32_bf16 v[140:143], a[236:239], v[44:47], v[140:143]
v_mfma_f32_16x16x32_bf16 v[144:147], a[208:211], v[64:67], 0
v_mfma_f32_16x16x32_bf16 v[144:147], a[240:243], v[44:47], v[144:147]
v_mfma_f32_16x16x32_bf16 v[148:151], a[212:215], v[64:67], 0
v_mfma_f32_16x16x32_bf16 v[148:151], a[244:247], v[44:47], v[148:151]
v_mfma_f32_16x16x32_bf16 v[152:155], a[216:219], v[64:67], 0
v_mfma_f32_16x16x32_bf16 v[152:155], a[248:251], v[44:47], v[152:155]
v_mfma_f32_16x16x32_bf16 v[156:159], a[220:223], v[64:67], 0
v_mfma_f32_16x16x32_bf16 v[156:159], a[252:255], v[44:47], v[156:159]
v_mfma_f32_16x16x32_bf16 v[36:39], v[32:35], v[64:67], 0
v_mfma_f32_16x16x32_bf16 v[36:39], v[32:35], v[44:47], v[36:39]
s_waitcnt vmcnt(4)
ds_read_b128 v[160:163], v14 offset:16640
ds_read_b128 v[164:167], v14 offset:16656
ds_read_b128 v[168:171], v14 offset:16672
ds_read_b128 v[172:175], v14 offset:16688
s_add_u32 m0, s27, 33280
s_nop 0
buffer_load_dwordx4 v6, s[12:15], s32 offen offset:0 nt lds
buffer_load_dwordx4 v7, s[12:15], s32 offen offset:1040 nt lds
buffer_load_dwordx4 v8, s[12:15], s32 offen offset:2080 nt lds
buffer_load_dwordx4 v9, s[12:15], s32 offen offset:3120 nt lds
s_waitcnt lgkmcnt(0)
v_lshlrev_b32 v176, 16, v160
v_and_b32 v177, 0xffff0000, v160
v_lshlrev_b32 v178, 16, v161
v_and_b32 v179, 0xffff0000, v161
v_lshlrev_b32 v180, 16, v162
v_and_b32 v181, 0xffff0000, v162
v_lshlrev_b32 v182, 16, v163
v_and_b32 v183, 0xffff0000, v163
v_lshlrev_b32 v184, 16, v164
v_and_b32 v185, 0xffff0000, v164
v_lshlrev_b32 v186, 16, v165
v_and_b32 v187, 0xffff0000, v165
v_lshlrev_b32 v188, 16, v166
v_and_b32 v189, 0xffff0000, v166
v_lshlrev_b32 v190, 16, v167
v_and_b32 v191, 0xffff0000, v167
v_pk_mul_f32 v[176:177], v[176:177], s[24:25]
v_pk_mul_f32 v[178:179], v[178:179], s[24:25]
v_pk_mul_f32 v[180:181], v[180:181], s[24:25]
v_pk_mul_f32 v[182:183], v[182:183], s[24:25]
v_pk_mul_f32 v[184:185], v[184:185], s[24:25]
v_pk_mul_f32 v[186:187], v[186:187], s[24:25]
v_pk_mul_f32 v[188:189], v[188:189], s[24:25]
v_pk_mul_f32 v[190:191], v[190:191], s[24:25]
v_cvt_pk_bf16_f32 v160, v176, v177
v_cvt_pk_bf16_f32 v161, v178, v179
v_cvt_pk_bf16_f32 v162, v180, v181
v_cvt_pk_bf16_f32 v163, v182, v183
v_cvt_pk_bf16_f32 v164, v184, v185
v_cvt_pk_bf16_f32 v165, v186, v187
v_cvt_pk_bf16_f32 v166, v188, v189
v_cvt_pk_bf16_f32 v167, v190, v191
v_accvgpr_write_b32 a16, v160
v_accvgpr_write_b32 a17, v161
v_accvgpr_write_b32 a18, v162
v_accvgpr_write_b32 a19, v163
v_accvgpr_write_b32 a20, v164
v_accvgpr_write_b32 a21, v165
v_accvgpr_write_b32 a22, v166
v_accvgpr_write_b32 a23, v167
v_lshlrev_b32 v176, 16, v168
v_and_b32 v177, 0xffff0000, v168
v_lshlrev_b32 v178, 16, v169
v_and_b32 v179, 0xffff0000, v169
v_lshlrev_b32 v180, 16, v170
v_and_b32 v181, 0xffff0000, v170
v_lshlrev_b32 v182, 16, v171
v_and_b32 v183, 0xffff0000, v171
v_lshlrev_b32 v184, 16, v172
v_and_b32 v185, 0xffff0000, v172
v_lshlrev_b32 v186, 16, v173
v_and_b32 v187, 0xffff0000, v173
v_lshlrev_b32 v188, 16, v174
v_and_b32 v189, 0xffff0000, v174
v_lshlrev_b32 v190, 16, v175
v_and_b32 v191, 0xffff0000, v175
v_pk_mul_f32 v[176:177], v[176:177], s[24:25]
v_pk_mul_f32 v[178:179], v[178:179], s[24:25]
v_pk_mul_f32 v[180:181], v[180:181], s[24:25]
v_pk_mul_f32 v[182:183], v[182:183], s[24:25]
v_pk_mul_f32 v[184:185], v[184:185], s[24:25]
v_pk_mul_f32 v[186:187], v[186:187], s[24:25]
v_pk_mul_f32 v[188:189], v[188:189], s[24:25]
v_pk_mul_f32 v[190:191], v[190:191], s[24:25]
v_cvt_pk_bf16_f32 v168, v176, v177
v_cvt_pk_bf16_f32 v169, v178, v179
v_cvt_pk_bf16_f32 v170, v180, v181
v_cvt_pk_bf16_f32 v171, v182, v183
v_cvt_pk_bf16_f32 v172, v184, v185
v_cvt_pk_bf16_f32 v173, v186, v187
v_cvt_pk_bf16_f32 v174, v188, v189
v_cvt_pk_bf16_f32 v175, v190, v191
v_accvgpr_write_b32 a24, v168
v_accvgpr_write_b32 a25, v169
v_accvgpr_write_b32 a26, v170
v_accvgpr_write_b32 a27, v171
v_accvgpr_write_b32 a28, v172
v_accvgpr_write_b32 a29, v173
v_accvgpr_write_b32 a30, v174
v_accvgpr_write_b32 a31, v175
v_mfma_f32_16x16x32_bf16 v[72:75], a[128:131], a[16:19], 0
v_mfma_f32_16x16x32_bf16 v[72:75], a[132:135], a[20:23], v[72:75]
v_mfma_f32_16x16x32_bf16 v[72:75], a[136:139], a[24:27], v[72:75]
v_mfma_f32_16x16x32_bf16 v[72:75], a[140:143], a[28:31], v[72:75]
v_mfma_f32_16x16x32_bf16 v[76:79], a[144:147], a[16:19], 0
v_mfma_f32_16x16x32_bf16 v[76:79], a[148:151], a[20:23], v[76:79]
v_mfma_f32_16x16x32_bf16 v[76:79], a[152:155], a[24:27], v[76:79]
v_mfma_f32_16x16x32_bf16 v[76:79], a[156:159], a[28:31], v[76:79]
v_mfma_f32_16x16x32_bf16 v[52:55], a[160:163], a[16:19], 0
v_mfma_f32_16x16x32_bf16 v[52:55], a[164:167], a[20:23], v[52:55]
v_mfma_f32_16x16x32_bf16 v[52:55], a[168:171], a[24:27], v[52:55]
v_mfma_f32_16x16x32_bf16 v[52:55], a[172:175], a[28:31], v[52:55]
v_mfma_f32_16x16x32_bf16 v[56:59], a[176:179], a[16:19], 0
v_mfma_f32_16x16x32_bf16 v[56:59], a[180:183], a[20:23], v[56:59]
v_mfma_f32_16x16x32_bf16 v[56:59], a[184:187], a[24:27], v[56:59]
v_mfma_f32_16x16x32_bf16 v[56:59], a[188:191], a[28:31], v[56:59]
v_max3_f32 v26, v72, v73, v74
v_max3_f32 v26, v26, v75, v76
v_max3_f32 v26, v26, v77, v78
s_nop 0
v_max3_f32 v26, v26, v79, v52
v_max3_f32 v26, v26, v53, v54
s_nop 1
v_max3_f32 v26, v26, v55, v56
v_max3_f32 v26, v26, v57, v58
v_max_f32 v26, v26, v59
v_mov_b32 v27, v26
s_nop 1
v_permlane32_swap_b32 v26, v27
v_max_f32 v26, v26, v27
v_mov_b32 v27, v26
s_nop 1
v_permlane16_swap_b32 v26, v27
v_max_f32 v26, v26, v27
v_sub_f32 v100, 0, v26
v_sub_f32 v101, 0, v26
v_sub_f32 v102, 0, v26
v_sub_f32 v103, 0, v26
v_add_f32 v72, v72, v100
v_add_f32 v73, v73, v100
v_add_f32 v74, v74, v100
v_exp_f32 v72, v72
v_add_f32 v75, v75, v100
v_exp_f32 v73, v73
v_add_f32 v76, v76, v100
v_exp_f32 v74, v74
v_add_f32 v11, v11, v72
v_add_f32 v77, v77, v100
v_exp_f32 v75, v75
v_add_f32 v11, v11, v73
v_cvt_pk_bf16_f32 v72, v72, v73
v_add_f32 v78, v78, v100
v_exp_f32 v76, v76
v_add_f32 v11, v11, v74
v_add_f32 v79, v79, v100
v_exp_f32 v77, v77
v_add_f32 v11, v11, v75
v_cvt_pk_bf16_f32 v73, v74, v75
v_exp_f32 v78, v78
v_add_f32 v11, v11, v76
v_exp_f32 v79, v79
v_add_f32 v11, v11, v77
v_cvt_pk_bf16_f32 v74, v76, v77
v_add_f32 v11, v11, v78
v_add_f32 v11, v11, v79
v_cvt_pk_bf16_f32 v75, v78, v79
s_nop 1
v_mfma_f32_16x16x32_bf16 v[160:163], a[192:195], v[72:75], 0
v_add_f32 v52, v52, v100
v_add_f32 v53, v53, v100
v_add_f32 v54, v54, v100
v_mfma_f32_16x16x32_bf16 v[164:167], a[196:199], v[72:75], 0
v_exp_f32 v52, v52
v_add_f32 v55, v55, v100
v_exp_f32 v53, v53
v_add_f32 v56, v56, v100
v_mfma_f32_16x16x32_bf16 v[168:171], a[200:203], v[72:75], 0
v_exp_f32 v54, v54
v_add_f32 v11, v11, v52
v_add_f32 v57, v57, v100
v_mfma_f32_16x16x32_bf16 v[172:175], a[204:207], v[72:75], 0
v_exp_f32 v55, v55
v_add_f32 v11, v11, v53
v_cvt_pk_bf16_f32 v52, v52, v53
v_add_f32 v58, v58, v100
v_mfma_f32_16x16x32_bf16 v[176:179], a[208:211], v[72:75], 0
v_exp_f32 v56, v56
v_add_f32 v11, v11, v54
v_add_f32 v59, v59, v100
v_mfma_f32_16x16x32_bf16 v[180:183], a[212:215], v[72:75], 0
v_exp_f32 v57, v57
v_add_f32 v11, v11, v55
v_cvt_pk_bf16_f32 v53, v54, v55
v_exp_f32 v58, v58
v_mfma_f32_16x16x32_bf16 v[184:187], a[216:219], v[72:75], 0
v_add_f32 v11, v11, v56
v_exp_f32 v59, v59
v_add_f32 v11, v11, v57
v_mfma_f32_16x16x32_bf16 v[188:191], a[220:223], v[72:75], 0
v_cvt_pk_bf16_f32 v54, v56, v57
v_add_f32 v11, v11, v58
v_add_f32 v11, v11, v59
v_cvt_pk_bf16_f32 v55, v58, v59
s_waitcnt vmcnt(4)
ds_read_b128 v[192:195], v14 offset:33280
ds_read_b128 v[196:199], v14 offset:33296
ds_read_b128 v[200:203], v14 offset:33312
ds_read_b128 v[204:207], v14 offset:33328
s_add_u32 m0, s27, 133120
s_nop 0
buffer_load_dwordx4 v60, s[8:11], s34 offen offset:0 nt lds
buffer_load_dwordx4 v61, s[8:11], s34 offen offset:1040 nt lds
buffer_load_dwordx4 v62, s[8:11], s34 offen offset:2080 nt lds
buffer_load_dwordx4 v63, s[8:11], s34 offen offset:3120 nt lds
v_mfma_f32_16x16x32_bf16 v[160:163], a[224:227], v[52:55], v[160:163]
v_mfma_f32_16x16x32_bf16 v[164:167], a[228:231], v[52:55], v[164:167]
v_mfma_f32_16x16x32_bf16 v[168:171], a[232:235], v[52:55], v[168:171]
v_mfma_f32_16x16x32_bf16 v[172:175], a[236:239], v[52:55], v[172:175]
v_mfma_f32_16x16x32_bf16 v[176:179], a[240:243], v[52:55], v[176:179]
v_mfma_f32_16x16x32_bf16 v[180:183], a[244:247], v[52:55], v[180:183]
v_mfma_f32_16x16x32_bf16 v[184:187], a[248:251], v[52:55], v[184:187]
v_mfma_f32_16x16x32_bf16 v[188:191], a[252:255], v[52:55], v[188:191]
s_waitcnt lgkmcnt(0)
v_lshlrev_b32 v208, 16, v192
v_and_b32 v209, 0xffff0000, v192
v_lshlrev_b32 v210, 16, v193
v_and_b32 v211, 0xffff0000, v193
v_lshlrev_b32 v212, 16, v194
v_and_b32 v213, 0xffff0000, v194
v_lshlrev_b32 v214, 16, v195
v_and_b32 v215, 0xffff0000, v195
v_lshlrev_b32 v216, 16, v196
v_and_b32 v217, 0xffff0000, v196
v_lshlrev_b32 v218, 16, v197
v_and_b32 v219, 0xffff0000, v197
v_lshlrev_b32 v220, 16, v198
v_and_b32 v221, 0xffff0000, v198
v_lshlrev_b32 v222, 16, v199
v_and_b32 v223, 0xffff0000, v199
v_pk_mul_f32 v[208:209], v[208:209], s[24:25]
v_pk_mul_f32 v[210:211], v[210:211], s[24:25]
v_pk_mul_f32 v[212:213], v[212:213], s[24:25]
v_pk_mul_f32 v[214:215], v[214:215], s[24:25]
v_pk_mul_f32 v[216:217], v[216:217], s[24:25]
v_pk_mul_f32 v[218:219], v[218:219], s[24:25]
v_pk_mul_f32 v[220:221], v[220:221], s[24:25]
v_pk_mul_f32 v[222:223], v[222:223], s[24:25]
v_cvt_pk_bf16_f32 v192, v208, v209
v_cvt_pk_bf16_f32 v193, v210, v211
v_cvt_pk_bf16_f32 v194, v212, v213
v_cvt_pk_bf16_f32 v195, v214, v215
v_cvt_pk_bf16_f32 v196, v216, v217
v_cvt_pk_bf16_f32 v197, v218, v219
v_cvt_pk_bf16_f32 v198, v220, v221
v_cvt_pk_bf16_f32 v199, v222, v223
v_accvgpr_write_b32 a32, v192
v_accvgpr_write_b32 a33, v193
v_accvgpr_write_b32 a34, v194
v_accvgpr_write_b32 a35, v195
v_accvgpr_write_b32 a36, v196
v_accvgpr_write_b32 a37, v197
v_accvgpr_write_b32 a38, v198
v_accvgpr_write_b32 a39, v199
v_lshlrev_b32 v208, 16, v200
v_and_b32 v209, 0xffff0000, v200
v_lshlrev_b32 v210, 16, v201
v_and_b32 v211, 0xffff0000, v201
v_lshlrev_b32 v212, 16, v202
v_and_b32 v213, 0xffff0000, v202
v_lshlrev_b32 v214, 16, v203
v_and_b32 v215, 0xffff0000, v203
v_lshlrev_b32 v216, 16, v204
v_and_b32 v217, 0xffff0000, v204
v_lshlrev_b32 v218, 16, v205
v_and_b32 v219, 0xffff0000, v205
v_lshlrev_b32 v220, 16, v206
v_and_b32 v221, 0xffff0000, v206
v_lshlrev_b32 v222, 16, v207
v_and_b32 v223, 0xffff0000, v207
v_pk_mul_f32 v[208:209], v[208:209], s[24:25]
v_pk_mul_f32 v[210:211], v[210:211], s[24:25]
v_pk_mul_f32 v[212:213], v[212:213], s[24:25]
v_pk_mul_f32 v[214:215], v[214:215], s[24:25]
v_pk_mul_f32 v[216:217], v[216:217], s[24:25]
v_pk_mul_f32 v[218:219], v[218:219], s[24:25]
v_pk_mul_f32 v[220:221], v[220:221], s[24:25]
v_pk_mul_f32 v[222:223], v[222:223], s[24:25]
v_cvt_pk_bf16_f32 v200, v208, v209
v_cvt_pk_bf16_f32 v201, v210, v211
v_cvt_pk_bf16_f32 v202, v212, v213
v_cvt_pk_bf16_f32 v203, v214, v215
v_cvt_pk_bf16_f32 v204, v216, v217
v_cvt_pk_bf16_f32 v205, v218, v219
v_cvt_pk_bf16_f32 v206, v220, v221
v_cvt_pk_bf16_f32 v207, v222, v223
v_accvgpr_write_b32 a40, v200
v_accvgpr_write_b32 a41, v201
v_accvgpr_write_b32 a42, v202
v_accvgpr_write_b32 a43, v203
v_accvgpr_write_b32 a44, v204
v_accvgpr_write_b32 a45, v205
v_accvgpr_write_b32 a46, v206
v_accvgpr_write_b32 a47, v207
v_mfma_f32_16x16x32_bf16 v[80:83], a[128:131], a[32:35], 0
v_mfma_f32_16x16x32_bf16 v[80:83], a[132:135], a[36:39], v[80:83]
v_mfma_f32_16x16x32_bf16 v[80:83], a[136:139], a[40:43], v[80:83]
v_mfma_f32_16x16x32_bf16 v[80:83], a[140:143], a[44:47], v[80:83]
v_mfma_f32_16x16x32_bf16 v[84:87], a[144:147], a[32:35], 0
v_mfma_f32_16x16x32_bf16 v[84:87], a[148:151], a[36:39], v[84:87]
v_mfma_f32_16x16x32_bf16 v[84:87], a[152:155], a[40:43], v[84:87]
v_mfma_f32_16x16x32_bf16 v[84:87], a[156:159], a[44:47], v[84:87]
v_mfma_f32_16x16x32_bf16 v[112:115], a[160:163], a[32:35], 0
v_mfma_f32_16x16x32_bf16 v[112:115], a[164:167], a[36:39], v[112:115]
v_mfma_f32_16x16x32_bf16 v[112:115], a[168:171], a[40:43], v[112:115]
v_mfma_f32_16x16x32_bf16 v[112:115], a[172:175], a[44:47], v[112:115]
v_mfma_f32_16x16x32_bf16 v[116:119], a[176:179], a[32:35], 0
v_mfma_f32_16x16x32_bf16 v[116:119], a[180:183], a[36:39], v[116:119]
v_mfma_f32_16x16x32_bf16 v[116:119], a[184:187], a[40:43], v[116:119]
v_mfma_f32_16x16x32_bf16 v[116:119], a[188:191], a[44:47], v[116:119]
v_max3_f32 v26, v80, v81, v82
v_max3_f32 v26, v26, v83, v84
v_max3_f32 v26, v26, v85, v86
s_nop 0
v_max3_f32 v26, v26, v87, v112
v_max3_f32 v26, v26, v113, v114
s_nop 1
v_max3_f32 v26, v26, v115, v116
v_max3_f32 v26, v26, v117, v118
v_max_f32 v26, v26, v119
v_mov_b32 v27, v26
s_nop 1
v_permlane32_swap_b32 v26, v27
v_max_f32 v26, v26, v27
v_mov_b32 v27, v26
s_nop 1
v_permlane16_swap_b32 v26, v27
v_max_f32 v26, v26, v27
v_sub_f32 v104, 0, v26
v_sub_f32 v105, 0, v26
v_sub_f32 v106, 0, v26
v_sub_f32 v107, 0, v26
v_add_f32 v80, v80, v104
v_add_f32 v81, v81, v104
v_add_f32 v82, v82, v104
v_exp_f32 v80, v80
v_add_f32 v83, v83, v104
v_exp_f32 v81, v81
v_add_f32 v84, v84, v104
v_exp_f32 v82, v82
v_add_f32 v85, v85, v104
v_exp_f32 v83, v83
v_cvt_pk_bf16_f32 v80, v80, v81
v_add_f32 v86, v86, v104
v_exp_f32 v84, v84
v_add_f32 v87, v87, v104
v_exp_f32 v85, v85
v_cvt_pk_bf16_f32 v81, v82, v83
v_exp_f32 v86, v86
v_exp_f32 v87, v87
v_cvt_pk_bf16_f32 v82, v84, v85
v_cvt_pk_bf16_f32 v83, v86, v87
s_nop 1
v_mfma_f32_16x16x32_bf16 v[192:195], a[192:195], v[80:83], 0
v_add_f32 v112, v112, v104
v_add_f32 v113, v113, v104
v_mfma_f32_16x16x32_bf16 v[196:199], a[196:199], v[80:83], 0
v_add_f32 v114, v114, v104
v_exp_f32 v112, v112
v_mfma_f32_16x16x32_bf16 v[200:203], a[200:203], v[80:83], 0
v_add_f32 v115, v115, v104
v_exp_f32 v113, v113
v_mfma_f32_16x16x32_bf16 v[204:207], a[204:207], v[80:83], 0
v_add_f32 v116, v116, v104
v_exp_f32 v114, v114
v_mfma_f32_16x16x32_bf16 v[208:211], a[208:211], v[80:83], 0
v_add_f32 v117, v117, v104
v_exp_f32 v115, v115
v_cvt_pk_bf16_f32 v112, v112, v113
v_mfma_f32_16x16x32_bf16 v[212:215], a[212:215], v[80:83], 0
v_add_f32 v118, v118, v104
v_exp_f32 v116, v116
v_mfma_f32_16x16x32_bf16 v[216:219], a[216:219], v[80:83], 0
v_add_f32 v119, v119, v104
v_exp_f32 v117, v117
v_mfma_f32_16x16x32_bf16 v[220:223], a[220:223], v[80:83], 0
v_cvt_pk_bf16_f32 v113, v114, v115
v_exp_f32 v118, v118
v_mfma_f32_16x16x32_bf16 v[40:43], v[32:35], v[80:83], 0
v_exp_f32 v119, v119
v_cvt_pk_bf16_f32 v114, v116, v117
v_cvt_pk_bf16_f32 v115, v118, v119
s_waitcnt vmcnt(4)
s_barrier
ds_read_b128 a[64:67], v3 offset:33280
ds_read_b128 a[68:71], v3 offset:33296
ds_read_b128 a[72:75], v3 offset:33312
ds_read_b128 a[76:79], v3 offset:33328
ds_read_b128 a[80:83], v3 offset:33536
ds_read_b128 a[84:87], v3 offset:33552
ds_read_b128 a[88:91], v3 offset:33568
ds_read_b128 a[92:95], v3 offset:33584
ds_read_b128 a[96:99], v3 offset:33792
ds_read_b128 a[100:103], v3 offset:33808
ds_read_b128 a[104:107], v3 offset:33824
ds_read_b128 a[108:111], v3 offset:33840
ds_read_b128 a[112:115], v3 offset:34048
ds_read_b128 a[116:119], v3 offset:34064
ds_read_b128 a[120:123], v3 offset:34080
ds_read_b128 a[124:127], v3 offset:34096
s_add_u32 m0, s27, 49920
s_nop 0
buffer_load_dwordx4 v6, s[16:19], s32 offen offset:0 nt lds
buffer_load_dwordx4 v7, s[16:19], s32 offen offset:1040 nt lds
buffer_load_dwordx4 v8, s[16:19], s32 offen offset:2080 nt lds
buffer_load_dwordx4 v9, s[16:19], s32 offen offset:3120 nt lds
v_mfma_f32_16x16x32_bf16 v[192:195], a[224:227], v[112:115], v[192:195]
v_mfma_f32_16x16x32_bf16 v[196:199], a[228:231], v[112:115], v[196:199]
v_mfma_f32_16x16x32_bf16 v[200:203], a[232:235], v[112:115], v[200:203]
v_mfma_f32_16x16x32_bf16 v[204:207], a[236:239], v[112:115], v[204:207]
v_mfma_f32_16x16x32_bf16 v[208:211], a[240:243], v[112:115], v[208:211]
v_mfma_f32_16x16x32_bf16 v[212:215], a[244:247], v[112:115], v[212:215]
v_mfma_f32_16x16x32_bf16 v[216:219], a[248:251], v[112:115], v[216:219]
v_mfma_f32_16x16x32_bf16 v[220:223], a[252:255], v[112:115], v[220:223]
v_mfma_f32_16x16x32_bf16 v[40:43], v[32:35], v[112:115], v[40:43]
s_waitcnt lgkmcnt(8)
v_mfma_f32_16x16x32_bf16 v[64:67], a[64:67], a[0:3], v[96:99]
v_mfma_f32_16x16x32_bf16 v[64:67], a[68:71], a[4:7], v[64:67]
v_mfma_f32_16x16x32_bf16 v[64:67], a[72:75], a[8:11], v[64:67]
v_mfma_f32_16x16x32_bf16 v[64:67], a[76:79], a[12:15], v[64:67]
v_mfma_f32_16x16x32_bf16 v[68:71], a[80:83], a[0:3], v[96:99]
v_mfma_f32_16x16x32_bf16 v[68:71], a[84:87], a[4:7], v[68:71]
v_mfma_f32_16x16x32_bf16 v[68:71], a[88:91], a[8:11], v[68:71]
v_mfma_f32_16x16x32_bf16 v[68:71], a[92:95], a[12:15], v[68:71]
s_waitcnt lgkmcnt(0)
v_mfma_f32_16x16x32_bf16 v[44:47], a[96:99], a[0:3], v[96:99]
v_mfma_f32_16x16x32_bf16 v[44:47], a[100:103], a[4:7], v[44:47]
v_mfma_f32_16x16x32_bf16 v[44:47], a[104:107], a[8:11], v[44:47]
v_exp_f32 v64, v64
v_mfma_f32_16x16x32_bf16 v[44:47], a[108:111], a[12:15], v[44:47]
v_exp_f32 v65, v65
v_mfma_f32_16x16x32_bf16 v[48:51], a[112:115], a[0:3], v[96:99]
v_exp_f32 v66, v66
v_mfma_f32_16x16x32_bf16 v[48:51], a[116:119], a[4:7], v[48:51]
v_exp_f32 v67, v67
v_mfma_f32_16x16x32_bf16 v[48:51], a[120:123], a[8:11], v[48:51]
v_cvt_pk_bf16_f32 v64, v64, v65
v_mfma_f32_16x16x32_bf16 v[48:51], a[124:127], a[12:15], v[48:51]
v_exp_f32 v68, v68
v_mfma_f32_16x16x32_bf16 v[72:75], a[64:67], a[16:19], v[100:103]
v_exp_f32 v69, v69
v_mfma_f32_16x16x32_bf16 v[72:75], a[68:71], a[20:23], v[72:75]
v_cvt_pk_bf16_f32 v65, v66, v67
v_mfma_f32_16x16x32_bf16 v[72:75], a[72:75], a[24:27], v[72:75]
v_exp_f32 v70, v70
v_mfma_f32_16x16x32_bf16 v[72:75], a[76:79], a[28:31], v[72:75]
v_exp_f32 v71, v71
v_mfma_f32_16x16x32_bf16 v[76:79], a[80:83], a[16:19], v[100:103]
v_cvt_pk_bf16_f32 v66, v68, v69
v_cvt_pk_bf16_f32 v67, v70, v71
v_mfma_f32_16x16x32_bf16 v[76:79], a[84:87], a[20:23], v[76:79]
v_exp_f32 v44, v44
v_mfma_f32_16x16x32_bf16 v[76:79], a[88:91], a[24:27], v[76:79]
v_exp_f32 v45, v45
v_mfma_f32_16x16x32_bf16 v[76:79], a[92:95], a[28:31], v[76:79]
v_exp_f32 v46, v46
v_mfma_f32_16x16x32_bf16 v[52:55], a[96:99], a[16:19], v[100:103]
v_exp_f32 v47, v47
v_mfma_f32_16x16x32_bf16 v[52:55], a[100:103], a[20:23], v[52:55]
v_cvt_pk_bf16_f32 v44, v44, v45
v_mfma_f32_16x16x32_bf16 v[52:55], a[104:107], a[24:27], v[52:55]
v_exp_f32 v48, v48
v_mfma_f32_16x16x32_bf16 v[52:55], a[108:111], a[28:31], v[52:55]
v_exp_f32 v49, v49
v_mfma_f32_16x16x32_bf16 v[56:59], a[112:115], a[16:19], v[100:103]
v_cvt_pk_bf16_f32 v45, v46, v47
v_mfma_f32_16x16x32_bf16 v[56:59], a[116:119], a[20:23], v[56:59]
v_exp_f32 v50, v50
v_mfma_f32_16x16x32_bf16 v[56:59], a[120:123], a[24:27], v[56:59]
v_exp_f32 v51, v51
v_mfma_f32_16x16x32_bf16 v[56:59], a[124:127], a[28:31], v[56:59]
v_cvt_pk_bf16_f32 v46, v48, v49
v_cvt_pk_bf16_f32 v47, v50, v51
v_mfma_f32_16x16x32_bf16 v[80:83], a[64:67], a[32:35], v[104:107]
v_exp_f32 v72, v72
v_exp_f32 v73, v73
v_mfma_f32_16x16x32_bf16 v[80:83], a[68:71], a[36:39], v[80:83]
v_exp_f32 v74, v74
v_add_f32 v11, v11, v72
v_exp_f32 v75, v75
v_mfma_f32_16x16x32_bf16 v[80:83], a[72:75], a[40:43], v[80:83]
v_add_f32 v11, v11, v73
v_cvt_pk_bf16_f32 v72, v72, v73
v_mfma_f32_16x16x32_bf16 v[80:83], a[76:79], a[44:47], v[80:83]
v_exp_f32 v76, v76
v_add_f32 v11, v11, v74
v_exp_f32 v77, v77
v_mfma_f32_16x16x32_bf16 v[84:87], a[80:83], a[32:35], v[104:107]
v_add_f32 v11, v11, v75
v_cvt_pk_bf16_f32 v73, v74, v75
v_mfma_f32_16x16x32_bf16 v[84:87], a[84:87], a[36:39], v[84:87]
v_exp_f32 v78, v78
v_add_f32 v11, v11, v76
v_exp_f32 v79, v79
v_mfma_f32_16x16x32_bf16 v[84:87], a[88:91], a[40:43], v[84:87]
v_add_f32 v11, v11, v77
v_cvt_pk_bf16_f32 v74, v76, v77
v_mfma_f32_16x16x32_bf16 v[84:87], a[92:95], a[44:47], v[84:87]
v_add_f32 v11, v11, v78
v_add_f32 v11, v11, v79
v_cvt_pk_bf16_f32 v75, v78, v79
v_mfma_f32_16x16x32_bf16 v[112:115], a[96:99], a[32:35], v[104:107]
v_exp_f32 v52, v52
v_exp_f32 v53, v53
v_mfma_f32_16x16x32_bf16 v[112:115], a[100:103], a[36:39], v[112:115]
v_exp_f32 v54, v54
v_add_f32 v11, v11, v52
v_exp_f32 v55, v55
v_mfma_f32_16x16x32_bf16 v[112:115], a[104:107], a[40:43], v[112:115]
v_add_f32 v11, v11, v53
v_cvt_pk_bf16_f32 v52, v52, v53
v_mfma_f32_16x16x32_bf16 v[112:115], a[108:111], a[44:47], v[112:115]
v_exp_f32 v56, v56
v_add_f32 v11, v11, v54
v_exp_f32 v57, v57
v_mfma_f32_16x16x32_bf16 v[116:119], a[112:115], a[32:35], v[104:107]
v_add_f32 v11, v11, v55
v_cvt_pk_bf16_f32 v53, v54, v55
v_mfma_f32_16x16x32_bf16 v[116:119], a[116:119], a[36:39], v[116:119]
v_exp_f32 v58, v58
v_add_f32 v11, v11, v56
v_exp_f32 v59, v59
v_mfma_f32_16x16x32_bf16 v[116:119], a[120:123], a[40:43], v[116:119]
v_add_f32 v11, v11, v57
v_cvt_pk_bf16_f32 v54, v56, v57
v_mfma_f32_16x16x32_bf16 v[116:119], a[124:127], a[44:47], v[116:119]
v_add_f32 v11, v11, v58
v_add_f32 v11, v11, v59
v_cvt_pk_bf16_f32 v55, v58, v59
s_add_u32 m0, s27, 66560
s_nop 0
buffer_load_dwordx4 v6, s[12:15], s33 offen offset:0 nt lds
buffer_load_dwordx4 v7, s[12:15], s33 offen offset:1040 nt lds
buffer_load_dwordx4 v8, s[12:15], s33 offen offset:2080 nt lds
buffer_load_dwordx4 v9, s[12:15], s33 offen offset:3120 nt lds
s_waitcnt vmcnt(8)
ds_read_b128 v[224:227], v14 offset:49920
ds_read_b128 v[228:231], v14 offset:49936
ds_read_b128 v[232:235], v14 offset:49952
ds_read_b128 v[236:239], v14 offset:49968
v_exp_f32 v80, v80
v_exp_f32 v81, v81
v_exp_f32 v82, v82
v_exp_f32 v83, v83
v_cvt_pk_bf16_f32 v80, v80, v81
v_exp_f32 v84, v84
v_exp_f32 v85, v85
v_cvt_pk_bf16_f32 v81, v82, v83
v_exp_f32 v86, v86
v_exp_f32 v87, v87
v_cvt_pk_bf16_f32 v82, v84, v85
v_cvt_pk_bf16_f32 v83, v86, v87
s_waitcnt lgkmcnt(0)
v_lshlrev_b32 v240, 16, v224
v_and_b32 v241, 0xffff0000, v224
v_lshlrev_b32 v242, 16, v225
v_and_b32 v243, 0xffff0000, v225
v_lshlrev_b32 v244, 16, v226
v_and_b32 v245, 0xffff0000, v226
v_lshlrev_b32 v246, 16, v227
v_and_b32 v247, 0xffff0000, v227
v_lshlrev_b32 v248, 16, v228
v_and_b32 v249, 0xffff0000, v228
v_lshlrev_b32 v250, 16, v229
v_and_b32 v251, 0xffff0000, v229
v_lshlrev_b32 v252, 16, v230
v_and_b32 v253, 0xffff0000, v230
v_lshlrev_b32 v254, 16, v231
v_and_b32 v255, 0xffff0000, v231
v_pk_mul_f32 v[240:241], v[240:241], s[24:25]
v_pk_mul_f32 v[242:243], v[242:243], s[24:25]
v_pk_mul_f32 v[244:245], v[244:245], s[24:25]
v_pk_mul_f32 v[246:247], v[246:247], s[24:25]
v_pk_mul_f32 v[248:249], v[248:249], s[24:25]
v_pk_mul_f32 v[250:251], v[250:251], s[24:25]
v_pk_mul_f32 v[252:253], v[252:253], s[24:25]
v_pk_mul_f32 v[254:255], v[254:255], s[24:25]
v_cvt_pk_bf16_f32 v224, v240, v241
v_cvt_pk_bf16_f32 v225, v242, v243
v_cvt_pk_bf16_f32 v226, v244, v245
v_cvt_pk_bf16_f32 v227, v246, v247
v_cvt_pk_bf16_f32 v228, v248, v249
v_cvt_pk_bf16_f32 v229, v250, v251
v_cvt_pk_bf16_f32 v230, v252, v253
v_cvt_pk_bf16_f32 v231, v254, v255
v_accvgpr_write_b32 a48, v224
v_accvgpr_write_b32 a49, v225
v_accvgpr_write_b32 a50, v226
v_accvgpr_write_b32 a51, v227
v_accvgpr_write_b32 a52, v228
v_accvgpr_write_b32 a53, v229
v_accvgpr_write_b32 a54, v230
v_accvgpr_write_b32 a55, v231
v_lshlrev_b32 v240, 16, v232
v_and_b32 v241, 0xffff0000, v232
v_lshlrev_b32 v242, 16, v233
v_and_b32 v243, 0xffff0000, v233
v_lshlrev_b32 v244, 16, v234
v_and_b32 v245, 0xffff0000, v234
v_lshlrev_b32 v246, 16, v235
v_and_b32 v247, 0xffff0000, v235
v_lshlrev_b32 v248, 16, v236
v_and_b32 v249, 0xffff0000, v236
v_lshlrev_b32 v250, 16, v237
v_and_b32 v251, 0xffff0000, v237
v_lshlrev_b32 v252, 16, v238
v_and_b32 v253, 0xffff0000, v238
v_lshlrev_b32 v254, 16, v239
v_and_b32 v255, 0xffff0000, v239
v_pk_mul_f32 v[240:241], v[240:241], s[24:25]
v_pk_mul_f32 v[242:243], v[242:243], s[24:25]
v_pk_mul_f32 v[244:245], v[244:245], s[24:25]
v_pk_mul_f32 v[246:247], v[246:247], s[24:25]
v_pk_mul_f32 v[248:249], v[248:249], s[24:25]
v_pk_mul_f32 v[250:251], v[250:251], s[24:25]
v_pk_mul_f32 v[252:253], v[252:253], s[24:25]
v_pk_mul_f32 v[254:255], v[254:255], s[24:25]
v_cvt_pk_bf16_f32 v232, v240, v241
v_cvt_pk_bf16_f32 v233, v242, v243
v_cvt_pk_bf16_f32 v234, v244, v245
v_cvt_pk_bf16_f32 v235, v246, v247
v_cvt_pk_bf16_f32 v236, v248, v249
v_cvt_pk_bf16_f32 v237, v250, v251
v_cvt_pk_bf16_f32 v238, v252, v253
v_cvt_pk_bf16_f32 v239, v254, v255
v_accvgpr_write_b32 a56, v232
v_accvgpr_write_b32 a57, v233
v_accvgpr_write_b32 a58, v234
v_accvgpr_write_b32 a59, v235
v_accvgpr_write_b32 a60, v236
v_accvgpr_write_b32 a61, v237
v_accvgpr_write_b32 a62, v238
v_accvgpr_write_b32 a63, v239
v_mfma_f32_16x16x32_bf16 v[88:91], a[128:131], a[48:51], 0
v_mfma_f32_16x16x32_bf16 v[88:91], a[132:135], a[52:55], v[88:91]
v_exp_f32 v112, v112
v_mfma_f32_16x16x32_bf16 v[88:91], a[136:139], a[56:59], v[88:91]
v_exp_f32 v113, v113
v_mfma_f32_16x16x32_bf16 v[88:91], a[140:143], a[60:63], v[88:91]
v_exp_f32 v114, v114
v_mfma_f32_16x16x32_bf16 v[92:95], a[144:147], a[48:51], 0
v_mfma_f32_16x16x32_bf16 v[92:95], a[148:151], a[52:55], v[92:95]
v_exp_f32 v115, v115
v_mfma_f32_16x16x32_bf16 v[92:95], a[152:155], a[56:59], v[92:95]
v_cvt_pk_bf16_f32 v112, v112, v113
v_mfma_f32_16x16x32_bf16 v[92:95], a[156:159], a[60:63], v[92:95]
v_exp_f32 v116, v116
v_mfma_f32_16x16x32_bf16 v[120:123], a[160:163], a[48:51], 0
v_mfma_f32_16x16x32_bf16 v[120:123], a[164:167], a[52:55], v[120:123]
v_exp_f32 v117, v117
v_mfma_f32_16x16x32_bf16 v[120:123], a[168:171], a[56:59], v[120:123]
v_cvt_pk_bf16_f32 v113, v114, v115
v_mfma_f32_16x16x32_bf16 v[120:123], a[172:175], a[60:63], v[120:123]
v_exp_f32 v118, v118
v_mfma_f32_16x16x32_bf16 v[124:127], a[176:179], a[48:51], 0
v_mfma_f32_16x16x32_bf16 v[124:127], a[180:183], a[52:55], v[124:127]
v_exp_f32 v119, v119
v_mfma_f32_16x16x32_bf16 v[124:127], a[184:187], a[56:59], v[124:127]
v_cvt_pk_bf16_f32 v114, v116, v117
v_mfma_f32_16x16x32_bf16 v[124:127], a[188:191], a[60:63], v[124:127]
v_cvt_pk_bf16_f32 v115, v118, v119
v_max3_f32 v26, v88, v89, v90
v_max3_f32 v26, v26, v91, v92
v_max3_f32 v26, v26, v93, v94
v_max3_f32 v26, v26, v95, v120
v_max3_f32 v26, v26, v121, v122
s_nop 1
v_max3_f32 v26, v26, v123, v124
v_max3_f32 v26, v26, v125, v126
v_max_f32 v26, v26, v127
v_mov_b32 v27, v26
s_nop 1
v_permlane32_swap_b32 v26, v27
v_max_f32 v26, v26, v27
v_mov_b32 v27, v26
s_nop 1
v_permlane16_swap_b32 v26, v27
v_max_f32 v26, v26, v27
v_sub_f32 v108, 0, v26
v_sub_f32 v109, 0, v26
v_sub_f32 v110, 0, v26
v_sub_f32 v111, 0, v26
v_add_f32 v88, v88, v108
v_add_f32 v89, v89, v108
v_add_f32 v90, v90, v108
v_exp_f32 v88, v88
v_add_f32 v91, v91, v108
v_exp_f32 v89, v89
v_add_f32 v92, v92, v108
v_exp_f32 v90, v90
v_add_f32 v13, v13, v88
v_add_f32 v93, v93, v108
v_exp_f32 v91, v91
v_add_f32 v13, v13, v89
v_cvt_pk_bf16_f32 v88, v88, v89
v_add_f32 v94, v94, v108
v_exp_f32 v92, v92
v_add_f32 v13, v13, v90
v_add_f32 v95, v95, v108
v_exp_f32 v93, v93
v_add_f32 v13, v13, v91
v_cvt_pk_bf16_f32 v89, v90, v91
v_exp_f32 v94, v94
v_add_f32 v13, v13, v92
v_exp_f32 v95, v95
v_add_f32 v13, v13, v93
v_cvt_pk_bf16_f32 v90, v92, v93
v_add_f32 v13, v13, v94
v_add_f32 v13, v13, v95
v_cvt_pk_bf16_f32 v91, v94, v95
s_nop 1
v_mfma_f32_16x16x32_bf16 v[224:227], a[192:195], v[88:91], 0
v_add_f32 v120, v120, v108
v_add_f32 v121, v121, v108
v_add_f32 v122, v122, v108
v_mfma_f32_16x16x32_bf16 v[228:231], a[196:199], v[88:91], 0
v_exp_f32 v120, v120
v_add_f32 v123, v123, v108
v_exp_f32 v121, v121
v_add_f32 v124, v124, v108
v_mfma_f32_16x16x32_bf16 v[232:235], a[200:203], v[88:91], 0
v_exp_f32 v122, v122
v_add_f32 v13, v13, v120
v_add_f32 v125, v125, v108
v_mfma_f32_16x16x32_bf16 v[236:239], a[204:207], v[88:91], 0
v_exp_f32 v123, v123
v_add_f32 v13, v13, v121
v_cvt_pk_bf16_f32 v120, v120, v121
v_add_f32 v126, v126, v108
v_mfma_f32_16x16x32_bf16 v[240:243], a[208:211], v[88:91], 0
v_exp_f32 v124, v124
v_add_f32 v13, v13, v122
v_add_f32 v127, v127, v108
v_mfma_f32_16x16x32_bf16 v[244:247], a[212:215], v[88:91], 0
v_exp_f32 v125, v125
v_add_f32 v13, v13, v123
v_cvt_pk_bf16_f32 v121, v122, v123
v_exp_f32 v126, v126
v_mfma_f32_16x16x32_bf16 v[248:251], a[216:219], v[88:91], 0
v_add_f32 v13, v13, v124
v_exp_f32 v127, v127
v_add_f32 v13, v13, v125
v_mfma_f32_16x16x32_bf16 v[252:255], a[220:223], v[88:91], 0
v_cvt_pk_bf16_f32 v122, v124, v125
v_add_f32 v13, v13, v126
v_add_f32 v13, v13, v127
v_cvt_pk_bf16_f32 v123, v126, v127
s_add_u32 m0, s27, 83200
s_nop 0
buffer_load_dwordx4 v6, s[16:19], s33 offen offset:0 nt lds
buffer_load_dwordx4 v7, s[16:19], s33 offen offset:1040 nt lds
buffer_load_dwordx4 v8, s[16:19], s33 offen offset:2080 nt lds
buffer_load_dwordx4 v9, s[16:19], s33 offen offset:3120 nt lds
s_waitcnt vmcnt(8)
s_barrier
ds_read_b64_tr_b16 a[128:129], v5 offset:49920
ds_read_b64_tr_b16 a[130:131], v5 offset:50176
ds_read_b64_tr_b16 a[160:161], v5 offset:50432
ds_read_b64_tr_b16 a[162:163], v5 offset:50688
ds_read_b64_tr_b16 a[132:133], v5 offset:49936
ds_read_b64_tr_b16 a[134:135], v5 offset:50192
ds_read_b64_tr_b16 a[164:165], v5 offset:50448
ds_read_b64_tr_b16 a[166:167], v5 offset:50704
ds_read_b64_tr_b16 a[136:137], v5 offset:49952
ds_read_b64_tr_b16 a[138:139], v5 offset:50208
ds_read_b64_tr_b16 a[168:169], v5 offset:50464
ds_read_b64_tr_b16 a[170:171], v5 offset:50720
ds_read_b64_tr_b16 a[140:141], v5 offset:49968
ds_read_b64_tr_b16 a[142:143], v5 offset:50224
ds_read_b64_tr_b16 a[172:173], v5 offset:50480
ds_read_b64_tr_b16 a[174:175], v5 offset:50736
ds_read_b64_tr_b16 a[144:145], v5 offset:49984
ds_read_b64_tr_b16 a[146:147], v5 offset:50240
ds_read_b64_tr_b16 a[176:177], v5 offset:50496
ds_read_b64_tr_b16 a[178:179], v5 offset:50752
ds_read_b64_tr_b16 a[148:149], v5 offset:50000
ds_read_b64_tr_b16 a[150:151], v5 offset:50256
ds_read_b64_tr_b16 a[180:181], v5 offset:50512
ds_read_b64_tr_b16 a[182:183], v5 offset:50768
ds_read_b64_tr_b16 a[152:153], v5 offset:50016
ds_read_b64_tr_b16 a[154:155], v5 offset:50272
ds_read_b64_tr_b16 a[184:185], v5 offset:50528
ds_read_b64_tr_b16 a[186:187], v5 offset:50784
ds_read_b64_tr_b16 a[156:157], v5 offset:50032
ds_read_b64_tr_b16 a[158:159], v5 offset:50288
ds_read_b64_tr_b16 a[188:189], v5 offset:50544
ds_read_b64_tr_b16 a[190:191], v5 offset:50800
v_mfma_f32_16x16x32_bf16 v[224:227], a[224:227], v[120:123], v[224:227]
v_mfma_f32_16x16x32_bf16 v[228:231], a[228:231], v[120:123], v[228:231]
v_mfma_f32_16x16x32_bf16 v[232:235], a[232:235], v[120:123], v[232:235]
v_mfma_f32_16x16x32_bf16 v[236:239], a[236:239], v[120:123], v[236:239]
v_mfma_f32_16x16x32_bf16 v[240:243], a[240:243], v[120:123], v[240:243]
v_mfma_f32_16x16x32_bf16 v[244:247], a[244:247], v[120:123], v[244:247]
v_mfma_f32_16x16x32_bf16 v[248:251], a[248:251], v[120:123], v[248:251]
v_mfma_f32_16x16x32_bf16 v[252:255], a[252:255], v[120:123], v[252:255]
v_mfma_f32_16x16x32_bf16 v[88:91], a[64:67], a[48:51], v[108:111]
v_mfma_f32_16x16x32_bf16 v[88:91], a[68:71], a[52:55], v[88:91]
v_mfma_f32_16x16x32_bf16 v[88:91], a[72:75], a[56:59], v[88:91]
v_mfma_f32_16x16x32_bf16 v[88:91], a[76:79], a[60:63], v[88:91]
v_mfma_f32_16x16x32_bf16 v[92:95], a[80:83], a[48:51], v[108:111]
v_mfma_f32_16x16x32_bf16 v[92:95], a[84:87], a[52:55], v[92:95]
v_mfma_f32_16x16x32_bf16 v[92:95], a[88:91], a[56:59], v[92:95]
v_mfma_f32_16x16x32_bf16 v[92:95], a[92:95], a[60:63], v[92:95]
v_mfma_f32_16x16x32_bf16 v[120:123], a[96:99], a[48:51], v[108:111]
v_mfma_f32_16x16x32_bf16 v[120:123], a[100:103], a[52:55], v[120:123]
v_mfma_f32_16x16x32_bf16 v[120:123], a[104:107], a[56:59], v[120:123]
v_mfma_f32_16x16x32_bf16 v[120:123], a[108:111], a[60:63], v[120:123]
v_mfma_f32_16x16x32_bf16 v[124:127], a[112:115], a[48:51], v[108:111]
v_mfma_f32_16x16x32_bf16 v[124:127], a[116:119], a[52:55], v[124:127]
v_mfma_f32_16x16x32_bf16 v[124:127], a[120:123], a[56:59], v[124:127]
v_mfma_f32_16x16x32_bf16 v[124:127], a[124:127], a[60:63], v[124:127]
s_waitcnt lgkmcnt(0)
v_mfma_f32_16x16x32_bf16 v[128:131], a[128:131], v[64:67], v[128:131]
v_exp_f32 v88, v88
v_mfma_f32_16x16x32_bf16 v[128:131], a[160:163], v[44:47], v[128:131]
v_exp_f32 v89, v89
v_mfma_f32_16x16x32_bf16 v[132:135], a[132:135], v[64:67], v[132:135]
v_exp_f32 v90, v90
v_mfma_f32_16x16x32_bf16 v[132:135], a[164:167], v[44:47], v[132:135]
v_add_f32 v13, v13, v88
v_mfma_f32_16x16x32_bf16 v[136:139], a[136:139], v[64:67], v[136:139]
v_exp_f32 v91, v91
v_mfma_f32_16x16x32_bf16 v[136:139], a[168:171], v[44:47], v[136:139]
v_add_f32 v13, v13, v89
v_mfma_f32_16x16x32_bf16 v[140:143], a[140:143], v[64:67], v[140:143]
v_cvt_pk_bf16_f32 v88, v88, v89
v_mfma_f32_16x16x32_bf16 v[140:143], a[172:175], v[44:47], v[140:143]
v_exp_f32 v92, v92
v_mfma_f32_16x16x32_bf16 v[144:147], a[144:147], v[64:67], v[144:147]
v_add_f32 v13, v13, v90
v_exp_f32 v93, v93
v_mfma_f32_16x16x32_bf16 v[144:147], a[176:179], v[44:47], v[144:147]
v_add_f32 v13, v13, v91
v_mfma_f32_16x16x32_bf16 v[148:151], a[148:151], v[64:67], v[148:151]
v_cvt_pk_bf16_f32 v89, v90, v91
v_mfma_f32_16x16x32_bf16 v[148:151], a[180:183], v[44:47], v[148:151]
v_exp_f32 v94, v94
v_mfma_f32_16x16x32_bf16 v[152:155], a[152:155], v[64:67], v[152:155]
v_add_f32 v13, v13, v92
v_mfma_f32_16x16x32_bf16 v[152:155], a[184:187], v[44:47], v[152:155]
v_exp_f32 v95, v95
v_mfma_f32_16x16x32_bf16 v[156:159], a[156:159], v[64:67], v[156:159]
v_add_f32 v13, v13, v93
v_mfma_f32_16x16x32_bf16 v[156:159], a[188:191], v[44:47], v[156:159]
v_cvt_pk_bf16_f32 v90, v92, v93
v_mfma_f32_16x16x32_bf16 v[36:39], v[32:35], v[64:67], v[36:39]
v_add_f32 v13, v13, v94
v_mfma_f32_16x16x32_bf16 v[36:39], v[32:35], v[44:47], v[36:39]
v_add_f32 v13, v13, v95
v_cvt_pk_bf16_f32 v91, v94, v95
s_add_u32 m0, s27, 99840
s_nop 0
buffer_load_dwordx4 v6, s[12:15], s34 offen offset:0 nt lds
buffer_load_dwordx4 v7, s[12:15], s34 offen offset:1040 nt lds
buffer_load_dwordx4 v8, s[12:15], s34 offen offset:2080 nt lds
buffer_load_dwordx4 v9, s[12:15], s34 offen offset:3120 nt lds
s_waitcnt vmcnt(8)
s_barrier
ds_read_b128 a[64:67], v2 offset:0
ds_read_b128 a[68:71], v2 offset:16
ds_read_b128 a[72:75], v2 offset:32
ds_read_b128 a[76:79], v2 offset:48
ds_read_b128 a[80:83], v2 offset:256
ds_read_b128 a[84:87], v2 offset:272
ds_read_b128 a[88:91], v2 offset:288
ds_read_b128 a[92:95], v2 offset:304
ds_read_b128 a[96:99], v2 offset:512
ds_read_b128 a[100:103], v2 offset:528
ds_read_b128 a[104:107], v2 offset:544
ds_read_b128 a[108:111], v2 offset:560
ds_read_b128 a[112:115], v2 offset:768
ds_read_b128 a[116:119], v2 offset:784
ds_read_b128 a[120:123], v2 offset:800
ds_read_b128 a[124:127], v2 offset:816
v_add_u32 v2, 99840, v3
v_mfma_f32_16x16x32_bf16 v[160:163], a[128:131], v[72:75], v[160:163]
v_exp_f32 v120, v120
v_mfma_f32_16x16x32_bf16 v[160:163], a[160:163], v[52:55], v[160:163]
v_exp_f32 v121, v121
v_mfma_f32_16x16x32_bf16 v[164:167], a[132:135], v[72:75], v[164:167]
v_exp_f32 v122, v122
v_mfma_f32_16x16x32_bf16 v[164:167], a[164:167], v[52:55], v[164:167]
v_add_f32 v13, v13, v120
v_exp_f32 v123, v123
v_mfma_f32_16x16x32_bf16 v[168:171], a[136:139], v[72:75], v[168:171]
v_add_f32 v13, v13, v121
v_mfma_f32_16x16x32_bf16 v[168:171], a[168:171], v[52:55], v[168:171]
v_cvt_pk_bf16_f32 v120, v120, v121
v_mfma_f32_16x16x32_bf16 v[172:175], a[140:143], v[72:75], v[172:175]
v_exp_f32 v124, v124
v_mfma_f32_16x16x32_bf16 v[172:175], a[172:175], v[52:55], v[172:175]
v_add_f32 v13, v13, v122
v_exp_f32 v125, v125
v_mfma_f32_16x16x32_bf16 v[176:179], a[144:147], v[72:75], v[176:179]
v_add_f32 v13, v13, v123
v_mfma_f32_16x16x32_bf16 v[176:179], a[176:179], v[52:55], v[176:179]
v_cvt_pk_bf16_f32 v121, v122, v123
v_mfma_f32_16x16x32_bf16 v[180:183], a[148:151], v[72:75], v[180:183]
v_exp_f32 v126, v126
v_mfma_f32_16x16x32_bf16 v[180:183], a[180:183], v[52:55], v[180:183]
v_add_f32 v13, v13, v124
v_exp_f32 v127, v127
v_mfma_f32_16x16x32_bf16 v[184:187], a[152:155], v[72:75], v[184:187]
v_add_f32 v13, v13, v125
v_mfma_f32_16x16x32_bf16 v[184:187], a[184:187], v[52:55], v[184:187]
v_cvt_pk_bf16_f32 v122, v124, v125
v_mfma_f32_16x16x32_bf16 v[188:191], a[156:159], v[72:75], v[188:191]
v_add_f32 v13, v13, v126
v_mfma_f32_16x16x32_bf16 v[188:191], a[188:191], v[52:55], v[188:191]
v_add_f32 v13, v13, v127
v_cvt_pk_bf16_f32 v123, v126, v127
s_waitcnt lgkmcnt(0)
v_mfma_f32_16x16x32_bf16 v[64:67], a[64:67], a[0:3], v[96:99]
v_mfma_f32_16x16x32_bf16 v[64:67], a[68:71], a[4:7], v[64:67]
v_mfma_f32_16x16x32_bf16 v[64:67], a[72:75], a[8:11], v[64:67]
v_mfma_f32_16x16x32_bf16 v[64:67], a[76:79], a[12:15], v[64:67]
v_mfma_f32_16x16x32_bf16 v[68:71], a[80:83], a[0:3], v[96:99]
v_mfma_f32_16x16x32_bf16 v[68:71], a[84:87], a[4:7], v[68:71]
v_mfma_f32_16x16x32_bf16 v[68:71], a[88:91], a[8:11], v[68:71]
v_mfma_f32_16x16x32_bf16 v[68:71], a[92:95], a[12:15], v[68:71]
v_mfma_f32_16x16x32_bf16 v[44:47], a[96:99], a[0:3], v[96:99]
v_mfma_f32_16x16x32_bf16 v[44:47], a[100:103], a[4:7], v[44:47]
v_mfma_f32_16x16x32_bf16 v[44:47], a[104:107], a[8:11], v[44:47]
v_mfma_f32_16x16x32_bf16 v[44:47], a[108:111], a[12:15], v[44:47]
s_add_u32 m0, s27, 116480
v_exp_f32 v64, v64
v_mfma_f32_16x16x32_bf16 v[48:51], a[112:115], a[0:3], v[96:99]
v_exp_f32 v65, v65
v_mfma_f32_16x16x32_bf16 v[48:51], a[116:119], a[4:7], v[48:51]
v_exp_f32 v66, v66
v_mfma_f32_16x16x32_bf16 v[48:51], a[120:123], a[8:11], v[48:51]
buffer_load_dwordx4 v6, s[16:19], s34 offen offset:0 nt lds
v_mfma_f32_16x16x32_bf16 v[48:51], a[124:127], a[12:15], v[48:51]
v_exp_f32 v67, v67
v_mfma_f32_16x16x32_bf16 v[192:195], a[128:131], v[80:83], v[192:195]
v_cvt_pk_bf16_f32 v64, v64, v65
v_mfma_f32_16x16x32_bf16 v[192:195], a[160:163], v[112:115], v[192:195]
v_exp_f32 v68, v68
v_mfma_f32_16x16x32_bf16 v[196:199], a[132:135], v[80:83], v[196:199]
buffer_load_dwordx4 v7, s[16:19], s34 offen offset:1040 nt lds
v_mfma_f32_16x16x32_bf16 v[196:199], a[164:167], v[112:115], v[196:199]
v_exp_f32 v69, v69
v_mfma_f32_16x16x32_bf16 v[200:203], a[136:139], v[80:83], v[200:203]
v_cvt_pk_bf16_f32 v65, v66, v67
v_mfma_f32_16x16x32_bf16 v[200:203], a[168:171], v[112:115], v[200:203]
buffer_load_dwordx4 v8, s[16:19], s34 offen offset:2080 nt lds
v_exp_f32 v70, v70
v_mfma_f32_16x16x32_bf16 v[204:207], a[140:143], v[80:83], v[204:207]
v_mfma_f32_16x16x32_bf16 v[204:207], a[172:175], v[112:115], v[204:207]
v_exp_f32 v71, v71
v_mfma_f32_16x16x32_bf16 v[208:211], a[144:147], v[80:83], v[208:211]
buffer_load_dwordx4 v9, s[16:19], s34 offen offset:3120 nt lds
v_cvt_pk_bf16_f32 v66, v68, v69
v_mfma_f32_16x16x32_bf16 v[208:211], a[176:179], v[112:115], v[208:211]
v_cvt_pk_bf16_f32 v67, v70, v71
v_mfma_f32_16x16x32_bf16 v[212:215], a[148:151], v[80:83], v[212:215]
v_mfma_f32_16x16x32_bf16 v[212:215], a[180:183], v[112:115], v[212:215]
v_exp_f32 v44, v44
v_mfma_f32_16x16x32_bf16 v[216:219], a[152:155], v[80:83], v[216:219]
s_add_u32 m0, s27, 0
v_exp_f32 v45, v45
v_mfma_f32_16x16x32_bf16 v[216:219], a[184:187], v[112:115], v[216:219]
v_exp_f32 v46, v46
v_mfma_f32_16x16x32_bf16 v[220:223], a[156:159], v[80:83], v[220:223]
v_mfma_f32_16x16x32_bf16 v[220:223], a[188:191], v[112:115], v[220:223]
buffer_load_dwordx4 v6, s[12:15], s28 offen offset:0 nt lds
v_exp_f32 v47, v47
v_mfma_f32_16x16x32_bf16 v[40:43], v[32:35], v[80:83], v[40:43]
v_cvt_pk_bf16_f32 v44, v44, v45
v_mfma_f32_16x16x32_bf16 v[40:43], v[32:35], v[112:115], v[40:43]
v_exp_f32 v48, v48
v_mfma_f32_16x16x32_bf16 v[72:75], a[64:67], a[16:19], v[100:103]
v_mfma_f32_16x16x32_bf16 v[72:75], a[68:71], a[20:23], v[72:75]
buffer_load_dwordx4 v7, s[12:15], s28 offen offset:1040 nt lds
v_exp_f32 v49, v49
v_mfma_f32_16x16x32_bf16 v[72:75], a[72:75], a[24:27], v[72:75]
v_cvt_pk_bf16_f32 v45, v46, v47
v_mfma_f32_16x16x32_bf16 v[72:75], a[76:79], a[28:31], v[72:75]
v_exp_f32 v50, v50
v_mfma_f32_16x16x32_bf16 v[76:79], a[80:83], a[16:19], v[100:103]
buffer_load_dwordx4 v8, s[12:15], s28 offen offset:2080 nt lds
v_mfma_f32_16x16x32_bf16 v[76:79], a[84:87], a[20:23], v[76:79]
v_exp_f32 v51, v51
v_mfma_f32_16x16x32_bf16 v[76:79], a[88:91], a[24:27], v[76:79]
v_cvt_pk_bf16_f32 v46, v48, v49
v_mfma_f32_16x16x32_bf16 v[76:79], a[92:95], a[28:31], v[76:79]
buffer_load_dwordx4 v9, s[12:15], s28 offen offset:3120 nt lds
v_cvt_pk_bf16_f32 v47, v50, v51
v_mfma_f32_16x16x32_bf16 v[52:55], a[96:99], a[16:19], v[100:103]
v_mfma_f32_16x16x32_bf16 v[52:55], a[100:103], a[20:23], v[52:55]
v_mfma_f32_16x16x32_bf16 v[52:55], a[104:107], a[24:27], v[52:55]
v_exp_f32 v72, v72
v_mfma_f32_16x16x32_bf16 v[52:55], a[108:111], a[28:31], v[52:55]
v_exp_f32 v73, v73
v_exp_f32 v74, v74
v_mfma_f32_16x16x32_bf16 v[56:59], a[112:115], a[16:19], v[100:103]
v_add_f32 v11, v11, v72
v_exp_f32 v75, v75
v_mfma_f32_16x16x32_bf16 v[56:59], a[116:119], a[20:23], v[56:59]
v_add_f32 v11, v11, v73
v_cvt_pk_bf16_f32 v72, v72, v73
v_mfma_f32_16x16x32_bf16 v[56:59], a[120:123], a[24:27], v[56:59]
v_exp_f32 v76, v76
v_add_f32 v11, v11, v74
v_mfma_f32_16x16x32_bf16 v[56:59], a[124:127], a[28:31], v[56:59]
v_add_f32 v11, v11, v75
v_cvt_pk_bf16_f32 v73, v74, v75
s_nop 1
L_loop0:
v_mfma_f32_16x16x32_bf16 v[224:227], a[128:131], v[88:91], v[224:227]
s_waitcnt vmcnt(8)
s_barrier
v_mfma_f32_16x16x32_bf16 v[224:227], a[160:163], v[120:123], v[224:227]
v_exp_f32 v77, v77
v_mfma_f32_16x16x32_bf16 v[228:231], a[132:135], v[88:91], v[228:231]
v_cvt_pk_bf16_f32 v74, v76, v77
ds_read_b64_tr_b16 a[128:129], v4 offset:16640
v_mfma_f32_16x16x32_bf16 v[228:231], a[164:167], v[120:123], v[228:231]
v_exp_f32 v78, v78
v_mfma_f32_16x16x32_bf16 v[232:235], a[136:139], v[88:91], v[232:235]
v_mfma_f32_16x16x32_bf16 v[232:235], a[168:171], v[120:123], v[232:235]
v_add_f32 v11, v11, v76
v_exp_f32 v79, v79
ds_read_b64_tr_b16 a[130:131], v4 offset:16896
v_mfma_f32_16x16x32_bf16 v[236:239], a[140:143], v[88:91], v[236:239]
v_cvt_pk_bf16_f32 v75, v78, v79
v_add_f32 v11, v11, v77
v_mfma_f32_16x16x32_bf16 v[236:239], a[172:175], v[120:123], v[236:239]
v_exp_f32 v52, v52
v_mfma_f32_16x16x32_bf16 v[240:243], a[144:147], v[88:91], v[240:243]
v_mfma_f32_16x16x32_bf16 v[240:243], a[176:179], v[120:123], v[240:243]
v_add_f32 v11, v11, v78
v_exp_f32 v53, v53
ds_read_b64_tr_b16 a[160:161], v4 offset:17152
v_mfma_f32_16x16x32_bf16 v[244:247], a[148:151], v[88:91], v[244:247]
v_mfma_f32_16x16x32_bf16 v[244:247], a[180:183], v[120:123], v[244:247]
v_exp_f32 v54, v54
v_mfma_f32_16x16x32_bf16 v[248:251], a[152:155], v[88:91], v[248:251]
v_add_f32 v11, v11, v79
ds_read_b64_tr_b16 a[162:163], v4 offset:17408
v_mfma_f32_16x16x32_bf16 v[248:251], a[184:187], v[120:123], v[248:251]
v_exp_f32 v55, v55
v_mfma_f32_16x16x32_bf16 v[252:255], a[156:159], v[88:91], v[252:255]
v_mfma_f32_16x16x32_bf16 v[252:255], a[188:191], v[120:123], v[252:255]
v_exp_f32 v56, v56
ds_read_b64_tr_b16 a[132:133], v4 offset:16656
v_mfma_f32_16x16x32_bf16 v[80:83], a[64:67], a[32:35], v[104:107]
v_mfma_f32_16x16x32_bf16 v[80:83], a[68:71], a[36:39], v[80:83]
v_exp_f32 v57, v57
ds_read_b64_tr_b16 a[134:135], v4 offset:16912
v_mfma_f32_16x16x32_bf16 v[80:83], a[72:75], a[40:43], v[80:83]
v_mfma_f32_16x16x32_bf16 v[80:83], a[76:79], a[44:47], v[80:83]
v_exp_f32 v58, v58
ds_read_b64_tr_b16 a[164:165], v4 offset:17168
v_mfma_f32_16x16x32_bf16 v[84:87], a[80:83], a[32:35], v[104:107]
v_mfma_f32_16x16x32_bf16 v[84:87], a[84:87], a[36:39], v[84:87]
v_exp_f32 v59, v59
ds_read_b64_tr_b16 a[166:167], v4 offset:17424
v_mfma_f32_16x16x32_bf16 v[84:87], a[88:91], a[40:43], v[84:87]
v_mfma_f32_16x16x32_bf16 v[84:87], a[92:95], a[44:47], v[84:87]
v_mfma_f32_16x16x32_bf16 v[112:115], a[96:99], a[32:35], v[104:107]
v_exp_f32 v80, v80
ds_read_b64_tr_b16 a[136:137], v4 offset:16672
v_mfma_f32_16x16x32_bf16 v[112:115], a[100:103], a[36:39], v[112:115]
v_mfma_f32_16x16x32_bf16 v[112:115], a[104:107], a[40:43], v[112:115]
v_exp_f32 v81, v81
ds_read_b64_tr_b16 a[138:139], v4 offset:16928
v_mfma_f32_16x16x32_bf16 v[112:115], a[108:111], a[44:47], v[112:115]
v_mfma_f32_16x16x32_bf16 v[116:119], a[112:115], a[32:35], v[104:107]
v_exp_f32 v82, v82
ds_read_b64_tr_b16 a[168:169], v4 offset:17184
v_mfma_f32_16x16x32_bf16 v[116:119], a[116:119], a[36:39], v[116:119]
v_mfma_f32_16x16x32_bf16 v[116:119], a[120:123], a[40:43], v[116:119]
v_exp_f32 v83, v83
ds_read_b64_tr_b16 a[170:171], v4 offset:17440
v_mfma_f32_16x16x32_bf16 v[116:119], a[124:127], a[44:47], v[116:119]
v_mfma_f32_16x16x32_bf16 v[36:39], v[32:35], v[64:67], v[36:39]
v_exp_f32 v84, v84
ds_read_b64_tr_b16 a[140:141], v4 offset:16688
v_mfma_f32_16x16x32_bf16 v[36:39], v[32:35], v[44:47], v[36:39]
s_waitcnt lgkmcnt(1)
v_mfma_f32_16x16x32_bf16 v[128:131], a[128:131], v[64:67], v[128:131]
v_mfma_f32_16x16x32_bf16 v[128:131], a[160:163], v[44:47], v[128:131]
v_mfma_f32_16x16x32_bf16 v[132:135], a[132:135], v[64:67], v[132:135]
v_exp_f32 v85, v85
ds_read_b64_tr_b16 a[142:143], v4 offset:16944
ds_read_b64_tr_b16 a[172:173], v4 offset:17200
ds_read_b64_tr_b16 a[174:175], v4 offset:17456
v_mfma_f32_16x16x32_bf16 v[132:135], a[164:167], v[44:47], v[132:135]
v_mfma_f32_16x16x32_bf16 v[136:139], a[136:139], v[64:67], v[136:139]
v_exp_f32 v86, v86
ds_read_b64_tr_b16 a[144:145], v4 offset:16704
ds_read_b64_tr_b16 a[146:147], v4 offset:16960
ds_read_b64_tr_b16 a[176:177], v4 offset:17216
ds_read_b64_tr_b16 a[178:179], v4 offset:17472
v_mfma_f32_16x16x32_bf16 v[136:139], a[168:171], v[44:47], v[136:139]
s_waitcnt lgkmcnt(4)
v_mfma_f32_16x16x32_bf16 v[140:143], a[140:143], v[64:67], v[140:143]
v_exp_f32 v87, v87
ds_read_b64_tr_b16 a[148:149], v4 offset:16720
ds_read_b64_tr_b16 a[150:151], v4 offset:16976
ds_read_b64_tr_b16 a[180:181], v4 offset:17232
ds_read_b64_tr_b16 a[182:183], v4 offset:17488
ds_read_b64_tr_b16 a[152:153], v4 offset:16736
ds_read_b64_tr_b16 a[154:155], v4 offset:16992
v_mfma_f32_16x16x32_bf16 v[140:143], a[172:175], v[44:47], v[140:143]
s_waitcnt lgkmcnt(6)
v_mfma_f32_16x16x32_bf16 v[144:147], a[144:147], v[64:67], v[144:147]
v_mfma_f32_16x16x32_bf16 v[144:147], a[176:179], v[44:47], v[144:147]
s_waitcnt lgkmcnt(0)
v_exp_f32 v112, v112
v_add_f32 v11, v11, v52
ds_read_b64_tr_b16 a[184:185], v4 offset:17248
ds_read_b64_tr_b16 a[186:187], v4 offset:17504
v_mfma_f32_16x16x32_bf16 v[148:151], a[148:151], v[64:67], v[148:151]
v_exp_f32 v113, v113
ds_read_b64_tr_b16 a[156:157], v4 offset:16752
ds_read_b64_tr_b16 a[158:159], v4 offset:17008
v_mfma_f32_16x16x32_bf16 v[148:151], a[180:183], v[44:47], v[148:151]
s_add_u32 m0, m0, 16640
v_cvt_pk_bf16_f32 v52, v52, v53
v_add_f32 v11, v11, v53
ds_read_b64_tr_b16 a[188:189], v4 offset:17264
ds_read_b64_tr_b16 a[190:191], v4 offset:17520
v_mfma_f32_16x16x32_bf16 v[152:155], a[152:155], v[64:67], v[152:155]
s_waitcnt lgkmcnt(2)
v_add_u32 v4, s29, v5
buffer_load_dwordx4 v6, s[16:19], s28 offen offset:0 nt lds
v_mfma_f32_16x16x32_bf16 v[152:155], a[184:187], v[44:47], v[152:155]
v_mfma_f32_16x16x32_bf16 v[156:159], a[156:159], v[64:67], v[156:159]
s_waitcnt lgkmcnt(0)
v_exp_f32 v114, v114
v_cvt_pk_bf16_f32 v53, v54, v55
v_add_f32 v11, v11, v54
v_mfma_f32_16x16x32_bf16 v[156:159], a[188:191], v[44:47], v[156:159]
v_exp_f32 v115, v115
v_mfma_f32_16x16x32_bf16 v[88:91], a[64:67], a[48:51], v[108:111]
v_cvt_pk_bf16_f32 v54, v56, v57
v_add_f32 v11, v11, v55
v_mfma_f32_16x16x32_bf16 v[88:91], a[68:71], a[52:55], v[88:91]
v_mfma_f32_16x16x32_bf16 v[88:91], a[72:75], a[56:59], v[88:91]
v_exp_f32 v116, v116
v_cvt_pk_bf16_f32 v55, v58, v59
v_cvt_pk_bf16_f32 v80, v80, v81
v_mfma_f32_16x16x32_bf16 v[88:91], a[76:79], a[60:63], v[88:91]
v_exp_f32 v117, v117
v_mfma_f32_16x16x32_bf16 v[92:95], a[80:83], a[48:51], v[108:111]
v_cvt_pk_bf16_f32 v81, v82, v83
v_cvt_pk_bf16_f32 v82, v84, v85
v_mfma_f32_16x16x32_bf16 v[92:95], a[84:87], a[52:55], v[92:95]
v_mfma_f32_16x16x32_bf16 v[92:95], a[88:91], a[56:59], v[92:95]
v_exp_f32 v118, v118
v_cvt_pk_bf16_f32 v83, v86, v87
v_cvt_pk_bf16_f32 v112, v112, v113
v_mfma_f32_16x16x32_bf16 v[92:95], a[92:95], a[60:63], v[92:95]
v_exp_f32 v119, v119
v_mfma_f32_16x16x32_bf16 v[120:123], a[96:99], a[48:51], v[108:111]
buffer_load_dwordx4 v7, s[16:19], s28 offen offset:1040 nt lds
v_mfma_f32_16x16x32_bf16 v[120:123], a[100:103], a[52:55], v[120:123]
v_exp_f32 v88, v88
v_mfma_f32_16x16x32_bf16 v[120:123], a[104:107], a[56:59], v[120:123]
v_cvt_pk_bf16_f32 v113, v114, v115
v_cvt_pk_bf16_f32 v114, v116, v117
v_mfma_f32_16x16x32_bf16 v[120:123], a[108:111], a[60:63], v[120:123]
v_mfma_f32_16x16x32_bf16 v[124:127], a[112:115], a[48:51], v[108:111]
v_exp_f32 v89, v89
v_cvt_pk_bf16_f32 v115, v118, v119
v_add_f32 v11, v11, v56
v_mfma_f32_16x16x32_bf16 v[124:127], a[116:119], a[52:55], v[124:127]
v_exp_f32 v90, v90
v_mfma_f32_16x16x32_bf16 v[124:127], a[120:123], a[56:59], v[124:127]
v_add_f32 v11, v11, v57
v_add_f32 v11, v11, v58
v_mfma_f32_16x16x32_bf16 v[124:127], a[124:127], a[60:63], v[124:127]
v_mfma_f32_16x16x32_bf16 v[160:163], a[128:131], v[72:75], v[160:163]
v_exp_f32 v91, v91
v_add_f32 v11, v11, v59
v_add_f32 v13, v13, v88
v_mfma_f32_16x16x32_bf16 v[160:163], a[160:163], v[52:55], v[160:163]
v_exp_f32 v92, v92
v_mfma_f32_16x16x32_bf16 v[164:167], a[132:135], v[72:75], v[164:167]
v_cvt_pk_bf16_f32 v88, v88, v89
v_add_f32 v13, v13, v89
v_mfma_f32_16x16x32_bf16 v[164:167], a[164:167], v[52:55], v[164:167]
v_exp_f32 v93, v93
v_mfma_f32_16x16x32_bf16 v[168:171], a[136:139], v[72:75], v[168:171]
buffer_load_dwordx4 v8, s[16:19], s28 offen offset:2080 nt lds
v_mfma_f32_16x16x32_bf16 v[168:171], a[168:171], v[52:55], v[168:171]
v_mfma_f32_16x16x32_bf16 v[172:175], a[140:143], v[72:75], v[172:175]
v_exp_f32 v94, v94
v_cvt_pk_bf16_f32 v89, v90, v91
v_add_f32 v13, v13, v90
v_mfma_f32_16x16x32_bf16 v[172:175], a[172:175], v[52:55], v[172:175]
v_exp_f32 v95, v95
v_mfma_f32_16x16x32_bf16 v[176:179], a[144:147], v[72:75], v[176:179]
v_mfma_f32_16x16x32_bf16 v[176:179], a[176:179], v[52:55], v[176:179]
v_exp_f32 v120, v120
ds_read_b128 a[64:67], v2 offset:0
v_mfma_f32_16x16x32_bf16 v[180:183], a[148:151], v[72:75], v[180:183]
v_mfma_f32_16x16x32_bf16 v[180:183], a[180:183], v[52:55], v[180:183]
v_exp_f32 v121, v121
ds_read_b128 a[68:71], v2 offset:16
v_mfma_f32_16x16x32_bf16 v[184:187], a[152:155], v[72:75], v[184:187]
v_mfma_f32_16x16x32_bf16 v[184:187], a[184:187], v[52:55], v[184:187]
v_exp_f32 v122, v122
ds_read_b128 a[72:75], v2 offset:32
v_mfma_f32_16x16x32_bf16 v[188:191], a[156:159], v[72:75], v[188:191]
v_mfma_f32_16x16x32_bf16 v[188:191], a[188:191], v[52:55], v[188:191]
s_waitcnt lgkmcnt(0)
v_exp_f32 v123, v123
ds_read_b128 a[76:79], v2 offset:48
ds_read_b128 a[80:83], v2 offset:256
ds_read_b128 a[84:87], v2 offset:272
v_mfma_f32_16x16x32_bf16 v[64:67], a[64:67], a[0:3], v[96:99]
buffer_load_dwordx4 v9, s[16:19], s28 offen offset:3120 nt lds
v_mfma_f32_16x16x32_bf16 v[64:67], a[68:71], a[4:7], v[64:67]
s_add_u32 s28, s28, 16384
v_mfma_f32_16x16x32_bf16 v[64:67], a[72:75], a[8:11], v[64:67]
s_waitcnt lgkmcnt(0)
v_exp_f32 v124, v124
ds_read_b128 a[88:91], v2 offset:288
ds_read_b128 a[92:95], v2 offset:304
v_mfma_f32_16x16x32_bf16 v[64:67], a[76:79], a[12:15], v[64:67]
v_mfma_f32_16x16x32_bf16 v[68:71], a[80:83], a[0:3], v[96:99]
v_exp_f32 v125, v125
ds_read_b128 a[96:99], v2 offset:512
ds_read_b128 a[100:103], v2 offset:528
v_mfma_f32_16x16x32_bf16 v[68:71], a[84:87], a[4:7], v[68:71]
s_waitcnt lgkmcnt(2)
v_mfma_f32_16x16x32_bf16 v[68:71], a[88:91], a[8:11], v[68:71]
v_exp_f32 v126, v126
ds_read_b128 a[104:107], v2 offset:544
ds_read_b128 a[108:111], v2 offset:560
v_mfma_f32_16x16x32_bf16 v[68:71], a[92:95], a[12:15], v[68:71]
s_waitcnt lgkmcnt(2)
v_mfma_f32_16x16x32_bf16 v[44:47], a[96:99], a[0:3], v[96:99]
v_exp_f32 v127, v127
ds_read_b128 a[112:115], v2 offset:768
v_mfma_f32_16x16x32_bf16 v[44:47], a[100:103], a[4:7], v[44:47]
s_waitcnt lgkmcnt(1)
v_cvt_pk_bf16_f32 v90, v92, v93
ds_read_b128 a[116:119], v2 offset:784
v_mfma_f32_16x16x32_bf16 v[44:47], a[104:107], a[8:11], v[44:47]
s_add_u32 m0, s35, s27
v_exp_f32 v64, v64
ds_read_b128 a[120:123], v2 offset:800
ds_read_b128 a[124:127], v2 offset:816
v_mfma_f32_16x16x32_bf16 v[44:47], a[108:111], a[12:15], v[44:47]
s_waitcnt lgkmcnt(2)
v_add_f32 v13, v13, v91
v_cvt_pk_bf16_f32 v91, v94, v95
v_add_u32 v2, s30, v3
buffer_load_dwordx4 v6, s[12:15], s28 offen offset:0 nt lds
v_mfma_f32_16x16x32_bf16 v[48:51], a[112:115], a[0:3], v[96:99]
v_mfma_f32_16x16x32_bf16 v[48:51], a[116:119], a[4:7], v[48:51]
s_waitcnt lgkmcnt(0)
v_mfma_f32_16x16x32_bf16 v[48:51], a[120:123], a[8:11], v[48:51]
v_exp_f32 v65, v65
v_add_f32 v13, v13, v92
v_add_f32 v13, v13, v93
v_mfma_f32_16x16x32_bf16 v[48:51], a[124:127], a[12:15], v[48:51]
v_exp_f32 v66, v66
v_mfma_f32_16x16x32_bf16 v[40:43], v[32:35], v[80:83], v[40:43]
v_add_f32 v13, v13, v94
v_add_f32 v13, v13, v95
v_mfma_f32_16x16x32_bf16 v[40:43], v[32:35], v[112:115], v[40:43]
v_mfma_f32_16x16x32_bf16 v[192:195], a[128:131], v[80:83], v[192:195]
v_exp_f32 v67, v67
v_add_f32 v13, v13, v120
v_cvt_pk_bf16_f32 v120, v120, v121
v_mfma_f32_16x16x32_bf16 v[192:195], a[160:163], v[112:115], v[192:195]
v_exp_f32 v68, v68
buffer_load_dwordx4 v7, s[12:15], s28 offen offset:1040 nt lds
v_mfma_f32_16x16x32_bf16 v[196:199], a[132:135], v[80:83], v[196:199]
v_add_f32 v13, v13, v121
v_cvt_pk_bf16_f32 v121, v122, v123
v_mfma_f32_16x16x32_bf16 v[196:199], a[164:167], v[112:115], v[196:199]
v_exp_f32 v69, v69
v_mfma_f32_16x16x32_bf16 v[200:203], a[136:139], v[80:83], v[200:203]
v_mfma_f32_16x16x32_bf16 v[200:203], a[168:171], v[112:115], v[200:203]
v_add_f32 v13, v13, v122
v_cvt_pk_bf16_f32 v122, v124, v125
v_exp_f32 v70, v70
v_mfma_f32_16x16x32_bf16 v[204:207], a[140:143], v[80:83], v[204:207]
v_add_f32 v13, v13, v123
v_cvt_pk_bf16_f32 v123, v126, v127
v_mfma_f32_16x16x32_bf16 v[204:207], a[172:175], v[112:115], v[204:207]
v_exp_f32 v71, v71
v_mfma_f32_16x16x32_bf16 v[208:211], a[144:147], v[80:83], v[208:211]
v_cvt_pk_bf16_f32 v64, v64, v65
v_cvt_pk_bf16_f32 v65, v66, v67
v_mfma_f32_16x16x32_bf16 v[208:211], a[176:179], v[112:115], v[208:211]
v_exp_f32 v44, v44
buffer_load_dwordx4 v8, s[12:15], s28 offen offset:2080 nt lds
v_mfma_f32_16x16x32_bf16 v[212:215], a[148:151], v[80:83], v[212:215]
v_mfma_f32_16x16x32_bf16 v[212:215], a[180:183], v[112:115], v[212:215]
v_cvt_pk_bf16_f32 v66, v68, v69
v_cvt_pk_bf16_f32 v67, v70, v71
v_exp_f32 v45, v45
v_mfma_f32_16x16x32_bf16 v[216:219], a[152:155], v[80:83], v[216:219]
v_cvt_pk_bf16_f32 v44, v44, v45
v_add_f32 v13, v13, v124
v_mfma_f32_16x16x32_bf16 v[216:219], a[184:187], v[112:115], v[216:219]
v_exp_f32 v46, v46
v_mfma_f32_16x16x32_bf16 v[220:223], a[156:159], v[80:83], v[220:223]
v_mfma_f32_16x16x32_bf16 v[220:223], a[188:191], v[112:115], v[220:223]
v_add_f32 v13, v13, v125
v_add_f32 v13, v13, v126
v_exp_f32 v47, v47
v_mfma_f32_16x16x32_bf16 v[72:75], a[64:67], a[16:19], v[100:103]
v_cvt_pk_bf16_f32 v45, v46, v47
v_add_f32 v13, v13, v127
v_mfma_f32_16x16x32_bf16 v[72:75], a[68:71], a[20:23], v[72:75]
v_exp_f32 v48, v48
buffer_load_dwordx4 v9, s[12:15], s28 offen offset:3120 nt lds
v_mfma_f32_16x16x32_bf16 v[72:75], a[72:75], a[24:27], v[72:75]
v_exp_f32 v49, v49
v_mfma_f32_16x16x32_bf16 v[72:75], a[76:79], a[28:31], v[72:75]
v_exp_f32 v50, v50
v_mfma_f32_16x16x32_bf16 v[76:79], a[80:83], a[16:19], v[100:103]
s_mov_b32 s29, s30
v_exp_f32 v51, v51
v_mfma_f32_16x16x32_bf16 v[76:79], a[84:87], a[20:23], v[76:79]
s_mov_b32 s30, s35
v_cvt_pk_bf16_f32 v46, v48, v49
v_cvt_pk_bf16_f32 v47, v50, v51
v_mfma_f32_16x16x32_bf16 v[76:79], a[88:91], a[24:27], v[76:79]
s_add_u32 s35, s35, 33280
v_mfma_f32_16x16x32_bf16 v[76:79], a[92:95], a[28:31], v[76:79]
s_cmp_eq_u32 s35, 133120
v_mfma_f32_16x16x32_bf16 v[52:55], a[96:99], a[16:19], v[100:103]
s_cselect_b32 s35, 0, s35
v_exp_f32 v72, v72
v_exp_f32 v73, v73
v_mfma_f32_16x16x32_bf16 v[52:55], a[100:103], a[20:23], v[52:55]
v_add_f32 v11, v11, v72
v_cvt_pk_bf16_f32 v72, v72, v73
v_mfma_f32_16x16x32_bf16 v[52:55], a[104:107], a[24:27], v[52:55]
v_exp_f32 v74, v74
v_mfma_f32_16x16x32_bf16 v[52:55], a[108:111], a[28:31], v[52:55]
v_add_f32 v11, v11, v73
v_add_f32 v11, v11, v74
v_mfma_f32_16x16x32_bf16 v[56:59], a[112:115], a[16:19], v[100:103]
v_exp_f32 v75, v75
v_mfma_f32_16x16x32_bf16 v[56:59], a[116:119], a[20:23], v[56:59]
s_cmp_lt_u32 s28, s39
v_cvt_pk_bf16_f32 v73, v74, v75
v_add_f32 v11, v11, v75
v_mfma_f32_16x16x32_bf16 v[56:59], a[120:123], a[24:27], v[56:59]
s_waitcnt lgkmcnt(0)
v_exp_f32 v76, v76
v_mfma_f32_16x16x32_bf16 v[56:59], a[124:127], a[28:31], v[56:59]
s_cbranch_scc1 L_loop0
.p2align 5
L_loop:
v_mfma_f32_16x16x32_bf16 v[224:227], a[128:131], v[88:91], v[224:227]
s_waitcnt vmcnt(8)
s_barrier
v_mfma_f32_16x16x32_bf16 v[224:227], a[160:163], v[120:123], v[224:227]
v_exp_f32 v77, v77
v_mfma_f32_16x16x32_bf16 v[228:231], a[132:135], v[88:91], v[228:231]
ds_read_b64_tr_b16 a[128:129], v4 offset:16640
v_cvt_pk_bf16_f32 v74, v76, v77
v_mfma_f32_16x16x32_bf16 v[228:231], a[164:167], v[120:123], v[228:231]
v_exp_f32 v78, v78
v_mfma_f32_16x16x32_bf16 v[232:235], a[136:139], v[88:91], v[232:235]
ds_read_b64_tr_b16 a[130:131], v4 offset:16896
v_add_f32 v11, v11, v76
v_mfma_f32_16x16x32_bf16 v[232:235], a[168:171], v[120:123], v[232:235]
v_exp_f32 v79, v79
v_mfma_f32_16x16x32_bf16 v[236:239], a[140:143], v[88:91], v[236:239]
v_cvt_pk_bf16_f32 v75, v78, v79
v_add_f32 v11, v11, v77
v_mfma_f32_16x16x32_bf16 v[236:239], a[172:175], v[120:123], v[236:239]
v_exp_f32 v52, v52
v_mfma_f32_16x16x32_bf16 v[240:243], a[144:147], v[88:91], v[240:243]
ds_read_b64_tr_b16 a[160:161], v4 offset:17152
v_add_f32 v11, v11, v78
v_mfma_f32_16x16x32_bf16 v[240:243], a[176:179], v[120:123], v[240:243]
s_add_u32 m0, m0, 16640
v_exp_f32 v53, v53
v_mfma_f32_16x16x32_bf16 v[244:247], a[148:151], v[88:91], v[244:247]
buffer_load_dwordx4 v6, s[16:19], s28 offen offset:0 nt lds
v_mfma_f32_16x16x32_bf16 v[244:247], a[180:183], v[120:123], v[244:247]
v_exp_f32 v54, v54
v_mfma_f32_16x16x32_bf16 v[248:251], a[152:155], v[88:91], v[248:251]
ds_read_b64_tr_b16 a[162:163], v4 offset:17408
v_add_f32 v11, v11, v79
v_mfma_f32_16x16x32_bf16 v[248:251], a[184:187], v[120:123], v[248:251]
v_exp_f32 v55, v55
v_mfma_f32_16x16x32_bf16 v[252:255], a[156:159], v[88:91], v[252:255]
ds_read_b64_tr_b16 a[132:133], v4 offset:16656
ds_read_b64_tr_b16 a[134:135], v4 offset:16912
v_mfma_f32_16x16x32_bf16 v[252:255], a[188:191], v[120:123], v[252:255]
v_exp_f32 v56, v56
v_mfma_f32_16x16x32_bf16 v[80:83], a[64:67], a[32:35], v[104:107]
ds_read_b64_tr_b16 a[164:165], v4 offset:17168
ds_read_b64_tr_b16 a[166:167], v4 offset:17424
v_mfma_f32_16x16x32_bf16 v[80:83], a[68:71], a[36:39], v[80:83]
v_exp_f32 v57, v57
v_mfma_f32_16x16x32_bf16 v[80:83], a[72:75], a[40:43], v[80:83]
ds_read_b64_tr_b16 a[136:137], v4 offset:16672
ds_read_b64_tr_b16 a[138:139], v4 offset:16928
v_mfma_f32_16x16x32_bf16 v[80:83], a[76:79], a[44:47], v[80:83]
v_exp_f32 v58, v58
v_mfma_f32_16x16x32_bf16 v[84:87], a[80:83], a[32:35], v[104:107]
ds_read_b64_tr_b16 a[168:169], v4 offset:17184
ds_read_b64_tr_b16 a[170:171], v4 offset:17440
v_mfma_f32_16x16x32_bf16 v[84:87], a[84:87], a[36:39], v[84:87]
v_exp_f32 v59, v59
v_mfma_f32_16x16x32_bf16 v[84:87], a[88:91], a[40:43], v[84:87]
buffer_load_dwordx4 v7, s[16:19], s28 offen offset:1040 nt lds
v_mfma_f32_16x16x32_bf16 v[84:87], a[92:95], a[44:47], v[84:87]
ds_read_b64_tr_b16 a[140:141], v4 offset:16688
ds_read_b64_tr_b16 a[142:143], v4 offset:16944
v_mfma_f32_16x16x32_bf16 v[112:115], a[96:99], a[32:35], v[104:107]
v_exp_f32 v80, v80
v_mfma_f32_16x16x32_bf16 v[112:115], a[100:103], a[36:39], v[112:115]
ds_read_b64_tr_b16 a[172:173], v4 offset:17200
ds_read_b64_tr_b16 a[174:175], v4 offset:17456
v_mfma_f32_16x16x32_bf16 v[112:115], a[104:107], a[40:43], v[112:115]
v_exp_f32 v81, v81
v_mfma_f32_16x16x32_bf16 v[112:115], a[108:111], a[44:47], v[112:115]
ds_read_b64_tr_b16 a[144:145], v4 offset:16704
ds_read_b64_tr_b16 a[146:147], v4 offset:16960
v_mfma_f32_16x16x32_bf16 v[116:119], a[112:115], a[32:35], v[104:107]
v_exp_f32 v82, v82
v_mfma_f32_16x16x32_bf16 v[116:119], a[116:119], a[36:39], v[116:119]
ds_read_b64_tr_b16 a[176:177], v4 offset:17216
ds_read_b64_tr_b16 a[178:179], v4 offset:17472
v_mfma_f32_16x16x32_bf16 v[116:119], a[120:123], a[40:43], v[116:119]
v_exp_f32 v83, v83
v_mfma_f32_16x16x32_bf16 v[116:119], a[124:127], a[44:47], v[116:119]
ds_read_b64_tr_b16 a[148:149], v4 offset:16720
ds_read_b64_tr_b16 a[150:151], v4 offset:16976
v_mfma_f32_16x16x32_bf16 v[36:39], v[32:35], v[64:67], v[36:39]
v_exp_f32 v84, v84
v_mfma_f32_16x16x32_bf16 v[36:39], v[32:35], v[44:47], v[36:39]
s_waitcnt lgkmcnt(4)
ds_read_b64_tr_b16 a[180:181], v4 offset:17232
ds_read_b64_tr_b16 a[182:183], v4 offset:17488
v_mfma_f32_16x16x32_bf16 v[128:131], a[128:131], v[64:67], v[128:131]
buffer_load_dwordx4 v8, s[16:19], s28 offen offset:2080 nt lds
v_mfma_f32_16x16x32_bf16 v[128:131], a[160:163], v[44:47], v[128:131]
ds_read_b64_tr_b16 a[152:153], v4 offset:16736
ds_read_b64_tr_b16 a[154:155], v4 offset:16992
v_mfma_f32_16x16x32_bf16 v[132:135], a[132:135], v[64:67], v[132:135]
v_exp_f32 v85, v85
v_mfma_f32_16x16x32_bf16 v[132:135], a[164:167], v[44:47], v[132:135]
ds_read_b64_tr_b16 a[184:185], v4 offset:17248
ds_read_b64_tr_b16 a[186:187], v4 offset:17504
v_mfma_f32_16x16x32_bf16 v[136:139], a[136:139], v[64:67], v[136:139]
v_exp_f32 v86, v86
v_mfma_f32_16x16x32_bf16 v[136:139], a[168:171], v[44:47], v[136:139]
ds_read_b64_tr_b16 a[156:157], v4 offset:16752
ds_read_b64_tr_b16 a[158:159], v4 offset:17008
v_mfma_f32_16x16x32_bf16 v[140:143], a[140:143], v[64:67], v[140:143]
v_exp_f32 v87, v87
v_mfma_f32_16x16x32_bf16 v[140:143], a[172:175], v[44:47], v[140:143]
ds_read_b64_tr_b16 a[188:189], v4 offset:17264
ds_read_b64_tr_b16 a[190:191], v4 offset:17520
v_mfma_f32_16x16x32_bf16 v[144:147], a[144:147], v[64:67], v[144:147]
s_waitcnt lgkmcnt(6)
v_exp_f32 v112, v112
v_mfma_f32_16x16x32_bf16 v[144:147], a[176:179], v[44:47], v[144:147]
v_add_u32 v4, s29, v5
v_add_f32 v11, v11, v52
v_mfma_f32_16x16x32_bf16 v[148:151], a[148:151], v[64:67], v[148:151]
v_exp_f32 v113, v113
v_mfma_f32_16x16x32_bf16 v[148:151], a[180:183], v[44:47], v[148:151]
v_cvt_pk_bf16_f32 v52, v52, v53
v_add_f32 v11, v11, v53
v_mfma_f32_16x16x32_bf16 v[152:155], a[152:155], v[64:67], v[152:155]
s_waitcnt lgkmcnt(2)
buffer_load_dwordx4 v9, s[16:19], s28 offen offset:3120 nt lds
v_mfma_f32_16x16x32_bf16 v[152:155], a[184:187], v[44:47], v[152:155]
s_add_u32 s28, s28, 16384
v_exp_f32 v114, v114
v_mfma_f32_16x16x32_bf16 v[156:159], a[156:159], v[64:67], v[156:159]
s_waitcnt lgkmcnt(0)
v_cvt_pk_bf16_f32 v53, v54, v55
v_add_f32 v11, v11, v54
v_mfma_f32_16x16x32_bf16 v[156:159], a[188:191], v[44:47], v[156:159]
v_exp_f32 v115, v115
v_mfma_f32_16x16x32_bf16 v[88:91], a[64:67], a[48:51], v[108:111]
v_cvt_pk_bf16_f32 v54, v56, v57
v_add_f32 v11, v11, v55
v_mfma_f32_16x16x32_bf16 v[88:91], a[68:71], a[52:55], v[88:91]
v_exp_f32 v116, v116
v_mfma_f32_16x16x32_bf16 v[88:91], a[72:75], a[56:59], v[88:91]
v_cvt_pk_bf16_f32 v55, v58, v59
v_cvt_pk_bf16_f32 v80, v80, v81
v_mfma_f32_16x16x32_bf16 v[88:91], a[76:79], a[60:63], v[88:91]
v_exp_f32 v117, v117
v_mfma_f32_16x16x32_bf16 v[92:95], a[80:83], a[48:51], v[108:111]
v_cvt_pk_bf16_f32 v81, v82, v83
v_cvt_pk_bf16_f32 v82, v84, v85
v_mfma_f32_16x16x32_bf16 v[92:95], a[84:87], a[52:55], v[92:95]
v_exp_f32 v118, v118
v_mfma_f32_16x16x32_bf16 v[92:95], a[88:91], a[56:59], v[92:95]
v_cvt_pk_bf16_f32 v83, v86, v87
v_cvt_pk_bf16_f32 v112, v112, v113
v_mfma_f32_16x16x32_bf16 v[92:95], a[92:95], a[60:63], v[92:95]
s_add_u32 m0, s35, s27
v_exp_f32 v119, v119
v_mfma_f32_16x16x32_bf16 v[120:123], a[96:99], a[48:51], v[108:111]
buffer_load_dwordx4 v6, s[12:15], s28 offen offset:0 nt lds
v_mfma_f32_16x16x32_bf16 v[120:123], a[100:103], a[52:55], v[120:123]
v_exp_f32 v88, v88
v_mfma_f32_16x16x32_bf16 v[120:123], a[104:107], a[56:59], v[120:123]
v_cvt_pk_bf16_f32 v113, v114, v115
v_cvt_pk_bf16_f32 v114, v116, v117
v_mfma_f32_16x16x32_bf16 v[120:123], a[108:111], a[60:63], v[120:123]
v_exp_f32 v89, v89
v_mfma_f32_16x16x32_bf16 v[124:127], a[112:115], a[48:51], v[108:111]
v_cvt_pk_bf16_f32 v115, v118, v119
v_add_f32 v11, v11, v56
v_mfma_f32_16x16x32_bf16 v[124:127], a[116:119], a[52:55], v[124:127]
v_exp_f32 v90, v90
v_mfma_f32_16x16x32_bf16 v[124:127], a[120:123], a[56:59], v[124:127]
v_add_f32 v11, v11, v57
v_add_f32 v11, v11, v58
v_mfma_f32_16x16x32_bf16 v[124:127], a[124:127], a[60:63], v[124:127]
v_exp_f32 v91, v91
v_mfma_f32_16x16x32_bf16 v[160:163], a[128:131], v[72:75], v[160:163]
v_add_f32 v11, v11, v59
v_add_f32 v13, v13, v88
v_mfma_f32_16x16x32_bf16 v[160:163], a[160:163], v[52:55], v[160:163]
v_exp_f32 v92, v92
v_mfma_f32_16x16x32_bf16 v[164:167], a[132:135], v[72:75], v[164:167]
v_cvt_pk_bf16_f32 v88, v88, v89
v_add_f32 v13, v13, v89
v_mfma_f32_16x16x32_bf16 v[164:167], a[164:167], v[52:55], v[164:167]
v_exp_f32 v93, v93
v_mfma_f32_16x16x32_bf16 v[168:171], a[136:139], v[72:75], v[168:171]
buffer_load_dwordx4 v7, s[12:15], s28 offen offset:1040 nt lds
v_mfma_f32_16x16x32_bf16 v[168:171], a[168:171], v[52:55], v[168:171]
v_exp_f32 v94, v94
v_mfma_f32_16x16x32_bf16 v[172:175], a[140:143], v[72:75], v[172:175]
v_cvt_pk_bf16_f32 v89, v90, v91
v_add_f32 v13, v13, v90
v_mfma_f32_16x16x32_bf16 v[172:175], a[172:175], v[52:55], v[172:175]
v_exp_f32 v95, v95
v_mfma_f32_16x16x32_bf16 v[176:179], a[144:147], v[72:75], v[176:179]
ds_read_b128 a[64:67], v2 offset:0
ds_read_b128 a[68:71], v2 offset:16
v_mfma_f32_16x16x32_bf16 v[176:179], a[176:179], v[52:55], v[176:179]
v_exp_f32 v120, v120
v_mfma_f32_16x16x32_bf16 v[180:183], a[148:151], v[72:75], v[180:183]
ds_read_b128 a[72:75], v2 offset:32
ds_read_b128 a[76:79], v2 offset:48
v_mfma_f32_16x16x32_bf16 v[180:183], a[180:183], v[52:55], v[180:183]
v_exp_f32 v121, v121
v_mfma_f32_16x16x32_bf16 v[184:187], a[152:155], v[72:75], v[184:187]
ds_read_b128 a[80:83], v2 offset:256
ds_read_b128 a[84:87], v2 offset:272
v_mfma_f32_16x16x32_bf16 v[184:187], a[184:187], v[52:55], v[184:187]
v_exp_f32 v122, v122
v_mfma_f32_16x16x32_bf16 v[188:191], a[156:159], v[72:75], v[188:191]
ds_read_b128 a[88:91], v2 offset:288
ds_read_b128 a[92:95], v2 offset:304
v_mfma_f32_16x16x32_bf16 v[188:191], a[188:191], v[52:55], v[188:191]
s_waitcnt lgkmcnt(6)
v_exp_f32 v123, v123
v_mfma_f32_16x16x32_bf16 v[64:67], a[64:67], a[0:3], v[96:99]
buffer_load_dwordx4 v8, s[12:15], s28 offen offset:2080 nt lds
v_mfma_f32_16x16x32_bf16 v[64:67], a[68:71], a[4:7], v[64:67]
s_waitcnt lgkmcnt(4)
ds_read_b128 a[96:99], v2 offset:512
ds_read_b128 a[100:103], v2 offset:528
v_mfma_f32_16x16x32_bf16 v[64:67], a[72:75], a[8:11], v[64:67]
v_exp_f32 v124, v124
v_mfma_f32_16x16x32_bf16 v[64:67], a[76:79], a[12:15], v[64:67]
s_waitcnt lgkmcnt(4)
ds_read_b128 a[104:107], v2 offset:544
ds_read_b128 a[108:111], v2 offset:560
v_mfma_f32_16x16x32_bf16 v[68:71], a[80:83], a[0:3], v[96:99]
v_exp_f32 v125, v125
v_mfma_f32_16x16x32_bf16 v[68:71], a[84:87], a[4:7], v[68:71]
s_waitcnt lgkmcnt(4)
ds_read_b128 a[112:115], v2 offset:768
ds_read_b128 a[116:119], v2 offset:784
v_mfma_f32_16x16x32_bf16 v[68:71], a[88:91], a[8:11], v[68:71]
v_exp_f32 v126, v126
v_mfma_f32_16x16x32_bf16 v[68:71], a[92:95], a[12:15], v[68:71]
s_waitcnt lgkmcnt(4)
ds_read_b128 a[120:123], v2 offset:800
ds_read_b128 a[124:127], v2 offset:816
v_mfma_f32_16x16x32_bf16 v[44:47], a[96:99], a[0:3], v[96:99]
v_exp_f32 v127, v127
v_mfma_f32_16x16x32_bf16 v[44:47], a[100:103], a[4:7], v[44:47]
s_waitcnt lgkmcnt(4)
v_cvt_pk_bf16_f32 v90, v92, v93
v_add_u32 v2, s30, v3
v_mfma_f32_16x16x32_bf16 v[44:47], a[104:107], a[8:11], v[44:47]
v_exp_f32 v64, v64
v_mfma_f32_16x16x32_bf16 v[44:47], a[108:111], a[12:15], v[44:47]
s_waitcnt lgkmcnt(2)
v_add_f32 v13, v13, v91
v_cvt_pk_bf16_f32 v91, v94, v95
v_mfma_f32_16x16x32_bf16 v[48:51], a[112:115], a[0:3], v[96:99]
buffer_load_dwordx4 v9, s[12:15], s28 offen offset:3120 nt lds
v_mfma_f32_16x16x32_bf16 v[48:51], a[116:119], a[4:7], v[48:51]
s_waitcnt lgkmcnt(0)
v_exp_f32 v65, v65
v_mfma_f32_16x16x32_bf16 v[48:51], a[120:123], a[8:11], v[48:51]
v_add_f32 v13, v13, v92
v_add_f32 v13, v13, v93
v_mfma_f32_16x16x32_bf16 v[48:51], a[124:127], a[12:15], v[48:51]
v_exp_f32 v66, v66
v_mfma_f32_16x16x32_bf16 v[40:43], v[32:35], v[80:83], v[40:43]
v_add_f32 v13, v13, v94
v_add_f32 v13, v13, v95
v_mfma_f32_16x16x32_bf16 v[40:43], v[32:35], v[112:115], v[40:43]
v_exp_f32 v67, v67
v_mfma_f32_16x16x32_bf16 v[192:195], a[128:131], v[80:83], v[192:195]
v_add_f32 v13, v13, v120
v_cvt_pk_bf16_f32 v120, v120, v121
v_mfma_f32_16x16x32_bf16 v[192:195], a[160:163], v[112:115], v[192:195]
v_exp_f32 v68, v68
v_mfma_f32_16x16x32_bf16 v[196:199], a[132:135], v[80:83], v[196:199]
v_add_f32 v13, v13, v121
v_cvt_pk_bf16_f32 v121, v122, v123
v_mfma_f32_16x16x32_bf16 v[196:199], a[164:167], v[112:115], v[196:199]
v_exp_f32 v69, v69
v_mfma_f32_16x16x32_bf16 v[200:203], a[136:139], v[80:83], v[200:203]
v_add_f32 v13, v13, v122
v_cvt_pk_bf16_f32 v122, v124, v125
v_mfma_f32_16x16x32_bf16 v[200:203], a[168:171], v[112:115], v[200:203]
v_exp_f32 v70, v70
v_mfma_f32_16x16x32_bf16 v[204:207], a[140:143], v[80:83], v[204:207]
v_add_f32 v13, v13, v123
v_cvt_pk_bf16_f32 v123, v126, v127
v_mfma_f32_16x16x32_bf16 v[204:207], a[172:175], v[112:115], v[204:207]
v_exp_f32 v71, v71
v_mfma_f32_16x16x32_bf16 v[208:211], a[144:147], v[80:83], v[208:211]
v_cvt_pk_bf16_f32 v64, v64, v65
v_cvt_pk_bf16_f32 v65, v66, v67
v_mfma_f32_16x16x32_bf16 v[208:211], a[176:179], v[112:115], v[208:211]
v_exp_f32 v44, v44
v_mfma_f32_16x16x32_bf16 v[212:215], a[148:151], v[80:83], v[212:215]
v_cvt_pk_bf16_f32 v66, v68, v69
v_cvt_pk_bf16_f32 v67, v70, v71
v_mfma_f32_16x16x32_bf16 v[212:215], a[180:183], v[112:115], v[212:215]
v_exp_f32 v45, v45
v_mfma_f32_16x16x32_bf16 v[216:219], a[152:155], v[80:83], v[216:219]
v_cvt_pk_bf16_f32 v44, v44, v45
v_add_f32 v13, v13, v124
v_mfma_f32_16x16x32_bf16 v[216:219], a[184:187], v[112:115], v[216:219]
v_exp_f32 v46, v46
v_mfma_f32_16x16x32_bf16 v[220:223], a[156:159], v[80:83], v[220:223]
v_add_f32 v13, v13, v125
v_add_f32 v13, v13, v126
v_mfma_f32_16x16x32_bf16 v[220:223], a[188:191], v[112:115], v[220:223]
v_exp_f32 v47, v47
v_mfma_f32_16x16x32_bf16 v[72:75], a[64:67], a[16:19], v[100:103]
v_cvt_pk_bf16_f32 v45, v46, v47
v_add_f32 v13, v13, v127
v_mfma_f32_16x16x32_bf16 v[72:75], a[68:71], a[20:23], v[72:75]
v_exp_f32 v48, v48
v_mfma_f32_16x16x32_bf16 v[72:75], a[72:75], a[24:27], v[72:75]
v_exp_f32 v49, v49
v_mfma_f32_16x16x32_bf16 v[72:75], a[76:79], a[28:31], v[72:75]
v_exp_f32 v50, v50
v_mfma_f32_16x16x32_bf16 v[76:79], a[80:83], a[16:19], v[100:103]
s_mov_b32 s29, s30
v_exp_f32 v51, v51
v_mfma_f32_16x16x32_bf16 v[76:79], a[84:87], a[20:23], v[76:79]
s_mov_b32 s30, s35
v_cvt_pk_bf16_f32 v46, v48, v49
v_cvt_pk_bf16_f32 v47, v50, v51
v_mfma_f32_16x16x32_bf16 v[76:79], a[88:91], a[24:27], v[76:79]
s_add_u32 s35, s35, 33280
v_mfma_f32_16x16x32_bf16 v[76:79], a[92:95], a[28:31], v[76:79]
s_cmp_eq_u32 s35, 133120
v_exp_f32 v72, v72
v_mfma_f32_16x16x32_bf16 v[52:55], a[96:99], a[16:19], v[100:103]
s_cselect_b32 s35, 0, s35
v_exp_f32 v73, v73
v_mfma_f32_16x16x32_bf16 v[52:55], a[100:103], a[20:23], v[52:55]
v_add_f32 v11, v11, v72
v_cvt_pk_bf16_f32 v72, v72, v73
v_mfma_f32_16x16x32_bf16 v[52:55], a[104:107], a[24:27], v[52:55]
v_exp_f32 v74, v74
v_mfma_f32_16x16x32_bf16 v[52:55], a[108:111], a[28:31], v[52:55]
v_add_f32 v11, v11, v73
v_add_f32 v11, v11, v74
v_mfma_f32_16x16x32_bf16 v[56:59], a[112:115], a[16:19], v[100:103]
v_exp_f32 v75, v75
v_mfma_f32_16x16x32_bf16 v[56:59], a[116:119], a[20:23], v[56:59]
s_cmp_lt_u32 s28, 278528
v_cvt_pk_bf16_f32 v73, v74, v75
v_add_f32 v11, v11, v75
v_mfma_f32_16x16x32_bf16 v[56:59], a[120:123], a[24:27], v[56:59]
s_waitcnt lgkmcnt(0)
v_exp_f32 v76, v76
v_mfma_f32_16x16x32_bf16 v[56:59], a[124:127], a[28:31], v[56:59]
s_cbranch_scc1 L_loop
v_mfma_f32_16x16x32_bf16 v[80:83], a[64:67], a[32:35], v[104:107]
s_waitcnt vmcnt(0)
s_barrier
v_mfma_f32_16x16x32_bf16 v[80:83], a[68:71], a[36:39], v[80:83]
ds_read_b64_tr_b16 a[192:193], v4 offset:16640
ds_read_b64_tr_b16 a[194:195], v4 offset:16896
v_mfma_f32_16x16x32_bf16 v[80:83], a[72:75], a[40:43], v[80:83]
ds_read_b64_tr_b16 a[224:225], v4 offset:17152
v_exp_f32 v77, v77
v_mfma_f32_16x16x32_bf16 v[80:83], a[76:79], a[44:47], v[80:83]
ds_read_b64_tr_b16 a[226:227], v4 offset:17408
v_exp_f32 v78, v78
v_mfma_f32_16x16x32_bf16 v[84:87], a[80:83], a[32:35], v[104:107]
ds_read_b64_tr_b16 a[196:197], v4 offset:16656
ds_read_b64_tr_b16 a[198:199], v4 offset:16912
v_mfma_f32_16x16x32_bf16 v[84:87], a[84:87], a[36:39], v[84:87]
ds_read_b64_tr_b16 a[228:229], v4 offset:17168
v_add_f32 v11, v11, v76
v_mfma_f32_16x16x32_bf16 v[84:87], a[88:91], a[40:43], v[84:87]
ds_read_b64_tr_b16 a[230:231], v4 offset:17424
v_exp_f32 v79, v79
v_mfma_f32_16x16x32_bf16 v[84:87], a[92:95], a[44:47], v[84:87]
ds_read_b64_tr_b16 a[200:201], v4 offset:16672
ds_read_b64_tr_b16 a[202:203], v4 offset:16928
v_mfma_f32_16x16x32_bf16 v[112:115], a[96:99], a[32:35], v[104:107]
ds_read_b64_tr_b16 a[232:233], v4 offset:17184
v_add_f32 v11, v11, v77
v_mfma_f32_16x16x32_bf16 v[112:115], a[100:103], a[36:39], v[112:115]
ds_read_b64_tr_b16 a[234:235], v4 offset:17440
v_cvt_pk_bf16_f32 v74, v76, v77
v_mfma_f32_16x16x32_bf16 v[112:115], a[104:107], a[40:43], v[112:115]
ds_read_b64_tr_b16 a[204:205], v4 offset:16688
ds_read_b64_tr_b16 a[206:207], v4 offset:16944
v_mfma_f32_16x16x32_bf16 v[112:115], a[108:111], a[44:47], v[112:115]
ds_read_b64_tr_b16 a[236:237], v4 offset:17200
v_add_f32 v11, v11, v78
v_mfma_f32_16x16x32_bf16 v[116:119], a[112:115], a[32:35], v[104:107]
ds_read_b64_tr_b16 a[238:239], v4 offset:17456
v_add_f32 v11, v11, v79
v_mfma_f32_16x16x32_bf16 v[116:119], a[116:119], a[36:39], v[116:119]
ds_read_b64_tr_b16 a[208:209], v4 offset:16704
ds_read_b64_tr_b16 a[210:211], v4 offset:16960
v_mfma_f32_16x16x32_bf16 v[116:119], a[120:123], a[40:43], v[116:119]
ds_read_b64_tr_b16 a[240:241], v4 offset:17216
v_cvt_pk_bf16_f32 v75, v78, v79
v_mfma_f32_16x16x32_bf16 v[116:119], a[124:127], a[44:47], v[116:119]
ds_read_b64_tr_b16 a[242:243], v4 offset:17472
v_exp_f32 v52, v52
v_mfma_f32_16x16x32_bf16 v[36:39], v[32:35], v[64:67], v[36:39]
ds_read_b64_tr_b16 a[212:213], v4 offset:16720
ds_read_b64_tr_b16 a[214:215], v4 offset:16976
v_mfma_f32_16x16x32_bf16 v[36:39], v[32:35], v[44:47], v[36:39]
s_waitcnt lgkmcnt(7)
ds_read_b64_tr_b16 a[244:245], v4 offset:17232
v_exp_f32 v53, v53
v_mfma_f32_16x16x32_bf16 v[128:131], a[192:195], v[64:67], v[128:131]
ds_read_b64_tr_b16 a[246:247], v4 offset:17488
v_exp_f32 v54, v54
v_mfma_f32_16x16x32_bf16 v[128:131], a[224:227], v[44:47], v[128:131]
ds_read_b64_tr_b16 a[216:217], v4 offset:16736
ds_read_b64_tr_b16 a[218:219], v4 offset:16992
v_mfma_f32_16x16x32_bf16 v[132:135], a[196:199], v[64:67], v[132:135]
ds_read_b64_tr_b16 a[248:249], v4 offset:17248
v_add_f32 v11, v11, v52
v_rcp_f32 v18, v36
s_nop 0
v_mfma_f32_16x16x32_bf16 v[132:135], a[228:231], v[44:47], v[132:135]
ds_read_b64_tr_b16 a[250:251], v4 offset:17504
v_exp_f32 v55, v55
v_mfma_f32_16x16x32_bf16 v[136:139], a[200:203], v[64:67], v[136:139]
ds_read_b64_tr_b16 a[220:221], v4 offset:16752
ds_read_b64_tr_b16 a[222:223], v4 offset:17008
v_mfma_f32_16x16x32_bf16 v[136:139], a[232:235], v[44:47], v[136:139]
ds_read_b64_tr_b16 a[252:253], v4 offset:17264
v_add_f32 v11, v11, v53
v_mfma_f32_16x16x32_bf16 v[140:143], a[204:207], v[64:67], v[140:143]
s_waitcnt lgkmcnt(7)
ds_read_b64_tr_b16 a[254:255], v4 offset:17520
v_cvt_pk_bf16_f32 v52, v52, v53
v_mfma_f32_16x16x32_bf16 v[140:143], a[236:239], v[44:47], v[140:143]
v_exp_f32 v80, v80
v_mfma_f32_16x16x32_bf16 v[144:147], a[208:211], v[64:67], v[144:147]
v_exp_f32 v56, v56
v_mfma_f32_16x16x32_bf16 v[144:147], a[240:243], v[44:47], v[144:147]
v_add_f32 v11, v11, v54
v_exp_f32 v57, v57
v_mfma_f32_16x16x32_bf16 v[148:151], a[212:215], v[64:67], v[148:151]
v_add_f32 v11, v11, v55
v_cvt_pk_bf16_f32 v53, v54, v55
v_mfma_f32_16x16x32_bf16 v[148:151], a[244:247], v[44:47], v[148:151]
s_waitcnt lgkmcnt(1)
v_exp_f32 v58, v58
v_mfma_f32_16x16x32_bf16 v[152:155], a[216:219], v[64:67], v[152:155]
v_add_f32 v11, v11, v56
v_exp_f32 v59, v59
v_mfma_f32_16x16x32_bf16 v[152:155], a[248:251], v[44:47], v[152:155]
v_add_f32 v11, v11, v57
v_cvt_pk_bf16_f32 v54, v56, v57
v_mfma_f32_16x16x32_bf16 v[156:159], a[220:223], v[64:67], v[156:159]
s_waitcnt lgkmcnt(0)
v_add_f32 v11, v11, v58
v_add_f32 v11, v11, v59
v_mfma_f32_16x16x32_bf16 v[156:159], a[252:255], v[44:47], v[156:159]
v_cvt_pk_bf16_f32 v55, v58, v59
v_exp_f32 v81, v81
v_mfma_f32_16x16x32_bf16 v[64:67], a[64:67], a[48:51], v[108:111]
v_exp_f32 v82, v82
v_mfma_f32_16x16x32_bf16 v[64:67], a[68:71], a[52:55], v[64:67]
v_exp_f32 v83, v83
v_mfma_f32_16x16x32_bf16 v[64:67], a[72:75], a[56:59], v[64:67]
v_cvt_pk_bf16_f32 v80, v80, v81
v_exp_f32 v84, v84
v_exp_f32 v85, v85
v_mfma_f32_16x16x32_bf16 v[64:67], a[76:79], a[60:63], v[64:67]
v_cvt_pk_bf16_f32 v81, v82, v83
v_exp_f32 v86, v86
v_exp_f32 v87, v87
v_mfma_f32_16x16x32_bf16 v[68:71], a[80:83], a[48:51], v[108:111]
v_cvt_pk_bf16_f32 v82, v84, v85
v_cvt_pk_bf16_f32 v83, v86, v87
v_exp_f32 v112, v112
v_pk_mul_f32 v[128:129], v[128:129], v[18:19] op_sel_hi:[1,0]
v_pk_mul_f32 v[130:131], v[130:131], v[18:19] op_sel_hi:[1,0]
v_pk_mul_f32 v[132:133], v[132:133], v[18:19] op_sel_hi:[1,0]
v_pk_mul_f32 v[134:135], v[134:135], v[18:19] op_sel_hi:[1,0]
v_pk_mul_f32 v[136:137], v[136:137], v[18:19] op_sel_hi:[1,0]
v_pk_mul_f32 v[138:139], v[138:139], v[18:19] op_sel_hi:[1,0]
v_pk_mul_f32 v[140:141], v[140:141], v[18:19] op_sel_hi:[1,0]
v_pk_mul_f32 v[142:143], v[142:143], v[18:19] op_sel_hi:[1,0]
v_pk_mul_f32 v[144:145], v[144:145], v[18:19] op_sel_hi:[1,0]
v_pk_mul_f32 v[146:147], v[146:147], v[18:19] op_sel_hi:[1,0]
v_pk_mul_f32 v[148:149], v[148:149], v[18:19] op_sel_hi:[1,0]
v_pk_mul_f32 v[150:151], v[150:151], v[18:19] op_sel_hi:[1,0]
v_pk_mul_f32 v[152:153], v[152:153], v[18:19] op_sel_hi:[1,0]
v_pk_mul_f32 v[154:155], v[154:155], v[18:19] op_sel_hi:[1,0]
v_pk_mul_f32 v[156:157], v[156:157], v[18:19] op_sel_hi:[1,0]
v_pk_mul_f32 v[158:159], v[158:159], v[18:19] op_sel_hi:[1,0]
v_mfma_f32_16x16x32_bf16 v[68:71], a[84:87], a[52:55], v[68:71]
v_cvt_pk_bf16_f32 v128, v128, v129
v_cvt_pk_bf16_f32 v129, v130, v131
v_cvt_pk_bf16_f32 v132, v132, v133
v_cvt_pk_bf16_f32 v133, v134, v135
v_cvt_pk_bf16_f32 v136, v136, v137
v_mfma_f32_16x16x32_bf16 v[68:71], a[88:91], a[56:59], v[68:71]
ds_write_b64 v15, v[128:129] offset:0
ds_write_b64 v15, v[132:133] offset:16
v_mfma_f32_16x16x32_bf16 v[68:71], a[92:95], a[60:63], v[68:71]
v_cvt_pk_bf16_f32 v137, v138, v139
v_cvt_pk_bf16_f32 v140, v140, v141
v_cvt_pk_bf16_f32 v141, v142, v143
v_cvt_pk_bf16_f32 v144, v144, v145
v_cvt_pk_bf16_f32 v145, v146, v147
v_mfma_f32_16x16x32_bf16 v[44:47], a[96:99], a[48:51], v[108:111]
ds_write_b64 v15, v[136:137] offset:32
ds_write_b64 v15, v[140:141] offset:48
ds_write_b64 v15, v[144:145] offset:64
v_mfma_f32_16x16x32_bf16 v[44:47], a[100:103], a[52:55], v[44:47]
v_cvt_pk_bf16_f32 v148, v148, v149
v_cvt_pk_bf16_f32 v149, v150, v151
v_cvt_pk_bf16_f32 v152, v152, v153
v_cvt_pk_bf16_f32 v153, v154, v155
v_cvt_pk_bf16_f32 v156, v156, v157
v_mfma_f32_16x16x32_bf16 v[44:47], a[104:107], a[56:59], v[44:47]
ds_write_b64 v15, v[148:149] offset:80
ds_write_b64 v15, v[152:153] offset:96
v_mfma_f32_16x16x32_bf16 v[44:47], a[108:111], a[60:63], v[44:47]
v_cvt_pk_bf16_f32 v157, v158, v159
v_exp_f32 v113, v113
v_mfma_f32_16x16x32_bf16 v[48:51], a[112:115], a[48:51], v[108:111]
ds_write_b64 v15, v[156:157] offset:112
ds_read_b128 v[128:131], v16 offset:0
v_mov_b32 v20, v11
v_mfma_f32_16x16x32_bf16 v[48:51], a[116:119], a[52:55], v[48:51]
ds_read_b128 v[132:135], v16 offset:1088
ds_read_b128 v[136:139], v16 offset:2176
s_nop 1
v_permlane32_swap_b32 v11, v20
v_mfma_f32_16x16x32_bf16 v[48:51], a[120:123], a[56:59], v[48:51]
ds_read_b128 v[140:143], v16 offset:3264
v_exp_f32 v114, v114
v_add_f32 v11, v11, v20
v_mov_b32 v20, v11
v_mfma_f32_16x16x32_bf16 v[48:51], a[124:127], a[60:63], v[48:51]
v_exp_f32 v115, v115
s_nop 1
v_permlane16_swap_b32 v11, v20
v_mfma_f32_16x16x32_bf16 v[160:163], a[192:195], v[72:75], v[160:163]
v_cvt_pk_bf16_f32 v112, v112, v113
v_exp_f32 v116, v116
v_add_f32 v11, v11, v20
v_rcp_f32 v20, v11
s_nop 0
v_mfma_f32_16x16x32_bf16 v[160:163], a[224:227], v[52:55], v[160:163]
v_exp_f32 v117, v117
v_mfma_f32_16x16x32_bf16 v[164:167], a[196:199], v[72:75], v[164:167]
v_cvt_pk_bf16_f32 v113, v114, v115
v_exp_f32 v118, v118
v_mfma_f32_16x16x32_bf16 v[164:167], a[228:231], v[52:55], v[164:167]
v_exp_f32 v119, v119
v_mfma_f32_16x16x32_bf16 v[168:171], a[200:203], v[72:75], v[168:171]
s_waitcnt lgkmcnt(0)
buffer_store_dwordx4 v[128:131], v6, s[20:23], 0 offen offset:0 sc0 sc1
v_mfma_f32_16x16x32_bf16 v[168:171], a[232:235], v[52:55], v[168:171]
v_cvt_pk_bf16_f32 v114, v116, v117
v_cvt_pk_bf16_f32 v115, v118, v119
v_mfma_f32_16x16x32_bf16 v[172:175], a[204:207], v[72:75], v[172:175]
v_exp_f32 v64, v64
v_mfma_f32_16x16x32_bf16 v[172:175], a[236:239], v[52:55], v[172:175]
v_exp_f32 v65, v65
v_mfma_f32_16x16x32_bf16 v[176:179], a[208:211], v[72:75], v[176:179]
buffer_store_dwordx4 v[132:135], v7, s[20:23], 0 offen offset:1040 sc0 sc1
v_mfma_f32_16x16x32_bf16 v[176:179], a[240:243], v[52:55], v[176:179]
v_exp_f32 v66, v66
v_mfma_f32_16x16x32_bf16 v[180:183], a[212:215], v[72:75], v[180:183]
v_add_f32 v13, v13, v64
v_exp_f32 v67, v67
v_mfma_f32_16x16x32_bf16 v[180:183], a[244:247], v[52:55], v[180:183]
v_add_f32 v13, v13, v65
v_cvt_pk_bf16_f32 v64, v64, v65
v_mfma_f32_16x16x32_bf16 v[184:187], a[216:219], v[72:75], v[184:187]
buffer_store_dwordx4 v[136:139], v8, s[20:23], 0 offen offset:2080 sc0 sc1
v_mfma_f32_16x16x32_bf16 v[184:187], a[248:251], v[52:55], v[184:187]
v_exp_f32 v68, v68
v_mfma_f32_16x16x32_bf16 v[188:191], a[220:223], v[72:75], v[188:191]
v_add_f32 v13, v13, v66
v_exp_f32 v69, v69
v_mfma_f32_16x16x32_bf16 v[188:191], a[252:255], v[52:55], v[188:191]
v_add_f32 v13, v13, v67
v_cvt_pk_bf16_f32 v65, v66, v67
v_mfma_f32_16x16x32_bf16 v[40:43], v[32:35], v[80:83], v[40:43]
buffer_store_dwordx4 v[140:143], v9, s[20:23], 0 offen offset:3120 sc0 sc1
v_mfma_f32_16x16x32_bf16 v[40:43], v[32:35], v[112:115], v[40:43]
v_exp_f32 v70, v70
v_mfma_f32_16x16x32_bf16 v[192:195], a[192:195], v[80:83], v[192:195]
v_add_f32 v13, v13, v68
v_exp_f32 v71, v71
v_add_f32 v13, v13, v69
v_pk_mul_f32 v[160:161], v[160:161], v[20:21] op_sel_hi:[1,0]
v_pk_mul_f32 v[162:163], v[162:163], v[20:21] op_sel_hi:[1,0]
v_pk_mul_f32 v[164:165], v[164:165], v[20:21] op_sel_hi:[1,0]
v_pk_mul_f32 v[166:167], v[166:167], v[20:21] op_sel_hi:[1,0]
v_pk_mul_f32 v[168:169], v[168:169], v[20:21] op_sel_hi:[1,0]
v_pk_mul_f32 v[170:171], v[170:171], v[20:21] op_sel_hi:[1,0]
v_pk_mul_f32 v[172:173], v[172:173], v[20:21] op_sel_hi:[1,0]
v_pk_mul_f32 v[174:175], v[174:175], v[20:21] op_sel_hi:[1,0]
v_pk_mul_f32 v[176:177], v[176:177], v[20:21] op_sel_hi:[1,0]
v_pk_mul_f32 v[178:179], v[178:179], v[20:21] op_sel_hi:[1,0]
v_pk_mul_f32 v[180:181], v[180:181], v[20:21] op_sel_hi:[1,0]
v_pk_mul_f32 v[182:183], v[182:183], v[20:21] op_sel_hi:[1,0]
v_pk_mul_f32 v[184:185], v[184:185], v[20:21] op_sel_hi:[1,0]
v_pk_mul_f32 v[186:187], v[186:187], v[20:21] op_sel_hi:[1,0]
v_pk_mul_f32 v[188:189], v[188:189], v[20:21] op_sel_hi:[1,0]
v_pk_mul_f32 v[190:191], v[190:191], v[20:21] op_sel_hi:[1,0]
v_mfma_f32_16x16x32_bf16 v[192:195], a[224:227], v[112:115], v[192:195]
v_cvt_pk_bf16_f32 v160, v160, v161
v_cvt_pk_bf16_f32 v161, v162, v163
v_cvt_pk_bf16_f32 v164, v164, v165
v_cvt_pk_bf16_f32 v165, v166, v167
v_cvt_pk_bf16_f32 v168, v168, v169
v_mfma_f32_16x16x32_bf16 v[196:199], a[196:199], v[80:83], v[196:199]
ds_write_b64 v15, v[160:161] offset:4352
ds_write_b64 v15, v[164:165] offset:4368
v_mfma_f32_16x16x32_bf16 v[196:199], a[228:231], v[112:115], v[196:199]
v_cvt_pk_bf16_f32 v169, v170, v171
v_cvt_pk_bf16_f32 v172, v172, v173
v_cvt_pk_bf16_f32 v173, v174, v175
v_cvt_pk_bf16_f32 v176, v176, v177
v_cvt_pk_bf16_f32 v177, v178, v179
v_mfma_f32_16x16x32_bf16 v[200:203], a[200:203], v[80:83], v[200:203]
ds_write_b64 v15, v[168:169] offset:4384
ds_write_b64 v15, v[172:173] offset:4400
ds_write_b64 v15, v[176:177] offset:4416
v_mfma_f32_16x16x32_bf16 v[200:203], a[232:235], v[112:115], v[200:203]
v_cvt_pk_bf16_f32 v180, v180, v181
v_cvt_pk_bf16_f32 v181, v182, v183
v_cvt_pk_bf16_f32 v184, v184, v185
v_cvt_pk_bf16_f32 v185, v186, v187
v_cvt_pk_bf16_f32 v188, v188, v189
v_mfma_f32_16x16x32_bf16 v[204:207], a[204:207], v[80:83], v[204:207]
ds_write_b64 v15, v[180:181] offset:4432
ds_write_b64 v15, v[184:185] offset:4448
v_mfma_f32_16x16x32_bf16 v[204:207], a[236:239], v[112:115], v[204:207]
v_cvt_pk_bf16_f32 v189, v190, v191
v_rcp_f32 v22, v40
s_nop 0
v_mfma_f32_16x16x32_bf16 v[208:211], a[208:211], v[80:83], v[208:211]
ds_write_b64 v15, v[188:189] offset:4464
ds_read_b128 v[160:163], v16 offset:4352
v_cvt_pk_bf16_f32 v66, v68, v69
v_mfma_f32_16x16x32_bf16 v[208:211], a[240:243], v[112:115], v[208:211]
ds_read_b128 v[164:167], v16 offset:5440
ds_read_b128 v[168:171], v16 offset:6528
v_add_f32 v13, v13, v70
v_add_f32 v13, v13, v71
v_mfma_f32_16x16x32_bf16 v[212:215], a[212:215], v[80:83], v[212:215]
ds_read_b128 v[172:175], v16 offset:7616
v_cvt_pk_bf16_f32 v67, v70, v71
v_mfma_f32_16x16x32_bf16 v[212:215], a[244:247], v[112:115], v[212:215]
v_exp_f32 v44, v44
v_mfma_f32_16x16x32_bf16 v[216:219], a[216:219], v[80:83], v[216:219]
v_exp_f32 v45, v45
v_mfma_f32_16x16x32_bf16 v[216:219], a[248:251], v[112:115], v[216:219]
v_exp_f32 v46, v46
v_mfma_f32_16x16x32_bf16 v[220:223], a[220:223], v[80:83], v[220:223]
v_add_f32 v13, v13, v44
v_exp_f32 v47, v47
v_mfma_f32_16x16x32_bf16 v[220:223], a[252:255], v[112:115], v[220:223]
v_add_f32 v13, v13, v45
v_cvt_pk_bf16_f32 v44, v44, v45
v_mfma_f32_16x16x32_bf16 v[224:227], a[128:131], v[88:91], v[224:227]
s_waitcnt lgkmcnt(0)
buffer_store_dwordx4 v[160:163], v6, s[20:23], s32 offen offset:0 sc0 sc1
v_mfma_f32_16x16x32_bf16 v[224:227], a[160:163], v[120:123], v[224:227]
v_exp_f32 v48, v48
v_mfma_f32_16x16x32_bf16 v[228:231], a[132:135], v[88:91], v[228:231]
v_add_f32 v13, v13, v46
v_exp_f32 v49, v49
v_add_f32 v13, v13, v47
v_pk_mul_f32 v[192:193], v[192:193], v[22:23] op_sel_hi:[1,0]
v_pk_mul_f32 v[194:195], v[194:195], v[22:23] op_sel_hi:[1,0]
v_pk_mul_f32 v[196:197], v[196:197], v[22:23] op_sel_hi:[1,0]
v_pk_mul_f32 v[198:199], v[198:199], v[22:23] op_sel_hi:[1,0]
v_pk_mul_f32 v[200:201], v[200:201], v[22:23] op_sel_hi:[1,0]
v_pk_mul_f32 v[202:203], v[202:203], v[22:23] op_sel_hi:[1,0]
v_pk_mul_f32 v[204:205], v[204:205], v[22:23] op_sel_hi:[1,0]
v_pk_mul_f32 v[206:207], v[206:207], v[22:23] op_sel_hi:[1,0]
v_pk_mul_f32 v[208:209], v[208:209], v[22:23] op_sel_hi:[1,0]
v_pk_mul_f32 v[210:211], v[210:211], v[22:23] op_sel_hi:[1,0]
v_pk_mul_f32 v[212:213], v[212:213], v[22:23] op_sel_hi:[1,0]
v_pk_mul_f32 v[214:215], v[214:215], v[22:23] op_sel_hi:[1,0]
v_pk_mul_f32 v[216:217], v[216:217], v[22:23] op_sel_hi:[1,0]
v_pk_mul_f32 v[218:219], v[218:219], v[22:23] op_sel_hi:[1,0]
v_pk_mul_f32 v[220:221], v[220:221], v[22:23] op_sel_hi:[1,0]
v_pk_mul_f32 v[222:223], v[222:223], v[22:23] op_sel_hi:[1,0]
v_mfma_f32_16x16x32_bf16 v[228:231], a[164:167], v[120:123], v[228:231]
v_cvt_pk_bf16_f32 v192, v192, v193
v_cvt_pk_bf16_f32 v193, v194, v195
v_cvt_pk_bf16_f32 v196, v196, v197
v_cvt_pk_bf16_f32 v197, v198, v199
v_cvt_pk_bf16_f32 v200, v200, v201
v_mfma_f32_16x16x32_bf16 v[232:235], a[136:139], v[88:91], v[232:235]
buffer_store_dwordx4 v[164:167], v7, s[20:23], s32 offen offset:1040 sc0 sc1
ds_write_b64 v15, v[192:193] offset:8704
ds_write_b64 v15, v[196:197] offset:8720
v_mfma_f32_16x16x32_bf16 v[232:235], a[168:171], v[120:123], v[232:235]
v_cvt_pk_bf16_f32 v201, v202, v203
v_cvt_pk_bf16_f32 v204, v204, v205
v_cvt_pk_bf16_f32 v205, v206, v207
v_cvt_pk_bf16_f32 v208, v208, v209
v_cvt_pk_bf16_f32 v209, v210, v211
v_mfma_f32_16x16x32_bf16 v[236:239], a[140:143], v[88:91], v[236:239]
ds_write_b64 v15, v[200:201] offset:8736
ds_write_b64 v15, v[204:205] offset:8752
ds_write_b64 v15, v[208:209] offset:8768
v_cvt_pk_bf16_f32 v45, v46, v47
v_mfma_f32_16x16x32_bf16 v[236:239], a[172:175], v[120:123], v[236:239]
v_exp_f32 v50, v50
v_cvt_pk_bf16_f32 v212, v212, v213
v_cvt_pk_bf16_f32 v213, v214, v215
v_cvt_pk_bf16_f32 v216, v216, v217
v_mfma_f32_16x16x32_bf16 v[240:243], a[144:147], v[88:91], v[240:243]
buffer_store_dwordx4 v[168:171], v8, s[20:23], s32 offen offset:2080 sc0 sc1
ds_write_b64 v15, v[212:213] offset:8784
v_add_f32 v13, v13, v48
v_mfma_f32_16x16x32_bf16 v[240:243], a[176:179], v[120:123], v[240:243]
v_exp_f32 v51, v51
v_cvt_pk_bf16_f32 v217, v218, v219
v_cvt_pk_bf16_f32 v220, v220, v221
v_cvt_pk_bf16_f32 v221, v222, v223
v_mfma_f32_16x16x32_bf16 v[244:247], a[148:151], v[88:91], v[244:247]
ds_write_b64 v15, v[216:217] offset:8800
ds_write_b64 v15, v[220:221] offset:8816
ds_read_b128 v[192:195], v16 offset:8704
v_add_f32 v13, v13, v49
v_mfma_f32_16x16x32_bf16 v[244:247], a[180:183], v[120:123], v[244:247]
ds_read_b128 v[196:199], v16 offset:9792
ds_read_b128 v[200:203], v16 offset:10880
v_cvt_pk_bf16_f32 v46, v48, v49
v_add_f32 v13, v13, v50
v_mfma_f32_16x16x32_bf16 v[248:251], a[152:155], v[88:91], v[248:251]
buffer_store_dwordx4 v[172:175], v9, s[20:23], s32 offen offset:3120 sc0 sc1
ds_read_b128 v[204:207], v16 offset:11968
v_add_f32 v13, v13, v51
v_mfma_f32_16x16x32_bf16 v[248:251], a[184:187], v[120:123], v[248:251]
v_cvt_pk_bf16_f32 v47, v50, v51
v_mov_b32 v24, v13
s_nop 1
v_permlane32_swap_b32 v13, v24
v_mfma_f32_16x16x32_bf16 v[252:255], a[156:159], v[88:91], v[252:255]
v_add_f32 v13, v13, v24
v_mov_b32 v24, v13
s_nop 1
v_permlane16_swap_b32 v13, v24
v_mfma_f32_16x16x32_bf16 v[252:255], a[188:191], v[120:123], v[252:255]
v_add_f32 v13, v13, v24
v_rcp_f32 v24, v13
s_nop 0
v_mfma_f32_16x16x32_bf16 v[224:227], a[192:195], v[64:67], v[224:227]
v_mfma_f32_16x16x32_bf16 v[224:227], a[224:227], v[44:47], v[224:227]
v_mfma_f32_16x16x32_bf16 v[228:231], a[196:199], v[64:67], v[228:231]
s_waitcnt lgkmcnt(0)
buffer_store_dwordx4 v[192:195], v6, s[20:23], s33 offen offset:0 sc0 sc1
v_mfma_f32_16x16x32_bf16 v[228:231], a[228:231], v[44:47], v[228:231]
v_mfma_f32_16x16x32_bf16 v[232:235], a[200:203], v[64:67], v[232:235]
s_nop 2
v_mul_f32 v224, v224, v24
v_mul_f32 v225, v225, v24
v_mul_f32 v226, v226, v24
v_mul_f32 v227, v227, v24
v_cvt_pk_bf16_f32 v224, v224, v225
v_mfma_f32_16x16x32_bf16 v[232:235], a[232:235], v[44:47], v[232:235]
v_cvt_pk_bf16_f32 v225, v226, v227
v_mfma_f32_16x16x32_bf16 v[236:239], a[204:207], v[64:67], v[236:239]
buffer_store_dwordx4 v[196:199], v7, s[20:23], s33 offen offset:1040 sc0 sc1
ds_write_b64 v15, v[224:225] offset:13056
v_mfma_f32_16x16x32_bf16 v[236:239], a[236:239], v[44:47], v[236:239]
v_mul_f32 v228, v228, v24
v_mul_f32 v229, v229, v24
v_mul_f32 v230, v230, v24
v_mul_f32 v231, v231, v24
v_cvt_pk_bf16_f32 v228, v228, v229
v_mfma_f32_16x16x32_bf16 v[240:243], a[208:211], v[64:67], v[240:243]
v_cvt_pk_bf16_f32 v229, v230, v231
v_mul_f32 v232, v232, v24
v_mul_f32 v233, v233, v24
v_mul_f32 v234, v234, v24
v_mul_f32 v235, v235, v24
v_mfma_f32_16x16x32_bf16 v[240:243], a[240:243], v[44:47], v[240:243]
ds_write_b64 v15, v[228:229] offset:13072
v_cvt_pk_bf16_f32 v232, v232, v233
v_cvt_pk_bf16_f32 v233, v234, v235
v_mfma_f32_16x16x32_bf16 v[244:247], a[212:215], v[64:67], v[244:247]
buffer_store_dwordx4 v[200:203], v8, s[20:23], s33 offen offset:2080 sc0 sc1
ds_write_b64 v15, v[232:233] offset:13088
v_mfma_f32_16x16x32_bf16 v[244:247], a[244:247], v[44:47], v[244:247]
v_mul_f32 v236, v236, v24
v_mul_f32 v237, v237, v24
v_mul_f32 v238, v238, v24
v_mul_f32 v239, v239, v24
v_cvt_pk_bf16_f32 v236, v236, v237
v_mfma_f32_16x16x32_bf16 v[248:251], a[216:219], v[64:67], v[248:251]
v_cvt_pk_bf16_f32 v237, v238, v239
v_mul_f32 v240, v240, v24
v_mul_f32 v241, v241, v24
v_mul_f32 v242, v242, v24
v_mul_f32 v243, v243, v24
v_mfma_f32_16x16x32_bf16 v[248:251], a[248:251], v[44:47], v[248:251]
ds_write_b64 v15, v[236:237] offset:13104
v_cvt_pk_bf16_f32 v240, v240, v241
v_cvt_pk_bf16_f32 v241, v242, v243
v_mfma_f32_16x16x32_bf16 v[252:255], a[220:223], v[64:67], v[252:255]
buffer_store_dwordx4 v[204:207], v9, s[20:23], s33 offen offset:3120 sc0 sc1
ds_write_b64 v15, v[240:241] offset:13120
v_mfma_f32_16x16x32_bf16 v[252:255], a[252:255], v[44:47], v[252:255]
v_mul_f32 v244, v244, v24
v_mul_f32 v245, v245, v24
v_mul_f32 v246, v246, v24
v_mul_f32 v247, v247, v24
v_cvt_pk_bf16_f32 v244, v244, v245
s_nop 3
v_cvt_pk_bf16_f32 v245, v246, v247
ds_write_b64 v15, v[244:245] offset:13136
v_pk_mul_f32 v[248:249], v[248:249], v[24:25] op_sel_hi:[1,0]
v_pk_mul_f32 v[250:251], v[250:251], v[24:25] op_sel_hi:[1,0]
v_cvt_pk_bf16_f32 v248, v248, v249
v_cvt_pk_bf16_f32 v249, v250, v251
v_pk_mul_f32 v[252:253], v[252:253], v[24:25] op_sel_hi:[1,0]
v_pk_mul_f32 v[254:255], v[254:255], v[24:25] op_sel_hi:[1,0]
v_cvt_pk_bf16_f32 v252, v252, v253
ds_write_b64 v15, v[248:249] offset:13152
v_cvt_pk_bf16_f32 v253, v254, v255
ds_write_b64 v15, v[252:253] offset:13168
ds_read_b128 v[224:227], v16 offset:13056
ds_read_b128 v[228:231], v16 offset:14144
ds_read_b128 v[232:235], v16 offset:15232
ds_read_b128 v[236:239], v16 offset:16320
s_waitcnt lgkmcnt(0)
buffer_store_dwordx4 v[224:227], v6, s[20:23], s34 offen offset:0 sc0 sc1
buffer_store_dwordx4 v[228:231], v7, s[20:23], s34 offen offset:1040 sc0 sc1
buffer_store_dwordx4 v[232:235], v8, s[20:23], s34 offen offset:2080 sc0 sc1
buffer_store_dwordx4 v[236:239], v9, s[20:23], s34 offen offset:3120 sc0 sc1
v_add_f32 v26, v36, v11
v_add_f32 v27, v40, v13
v_add_f32 v26, v26, v27
v_cmp_nge_f32 vcc, s26, v26
s_cbranch_vccnz L_fallback
L_end:
s_endpgm
L_fallback:
s_waitcnt vmcnt(0) lgkmcnt(0)
v_lshlrev_b32 v60, 4, v1
v_add_u32 v61, 3056, v60
v_add_u32 v62, 6112, v60
v_add_u32 v63, 9168, v60
v_add_u32 v2, s31, v3
v_add_u32 v4, s31, v5
v_mov_b32 v128, 0
v_mov_b32 v129, 0
v_mov_b32 v130, 0
v_mov_b32 v131, 0
v_mov_b32 v132, 0
v_mov_b32 v133, 0
v_mov_b32 v134, 0
v_mov_b32 v135, 0
v_mov_b32 v136, 0
v_mov_b32 v137, 0
v_mov_b32 v138, 0
v_mov_b32 v139, 0
v_mov_b32 v140, 0
v_mov_b32 v141, 0
v_mov_b32 v142, 0
v_mov_b32 v143, 0
v_mov_b32 v144, 0
v_mov_b32 v145, 0
v_mov_b32 v146, 0
v_mov_b32 v147, 0
v_mov_b32 v148, 0
v_mov_b32 v149, 0
v_mov_b32 v150, 0
v_mov_b32 v151, 0
v_mov_b32 v152, 0
v_mov_b32 v153, 0
v_mov_b32 v154, 0
v_mov_b32 v155, 0
v_mov_b32 v156, 0
v_mov_b32 v157, 0
v_mov_b32 v158, 0
v_mov_b32 v159, 0
v_mov_b32 v160, 0
v_mov_b32 v161, 0
v_mov_b32 v162, 0
v_mov_b32 v163, 0
v_mov_b32 v164, 0
v_mov_b32 v165, 0
v_mov_b32 v166, 0
v_mov_b32 v167, 0
v_mov_b32 v168, 0
v_mov_b32 v169, 0
v_mov_b32 v170, 0
v_mov_b32 v171, 0
v_mov_b32 v172, 0
v_mov_b32 v173, 0
v_mov_b32 v174, 0
v_mov_b32 v175, 0
v_mov_b32 v176, 0
v_mov_b32 v177, 0
v_mov_b32 v178, 0
v_mov_b32 v179, 0
v_mov_b32 v180, 0
v_mov_b32 v181, 0
v_mov_b32 v182, 0
v_mov_b32 v183, 0
v_mov_b32 v184, 0
v_mov_b32 v185, 0
v_mov_b32 v186, 0
v_mov_b32 v187, 0
v_mov_b32 v188, 0
v_mov_b32 v189, 0
v_mov_b32 v190, 0
v_mov_b32 v191, 0
v_mov_b32 v192, 0
v_mov_b32 v193, 0
v_mov_b32 v194, 0
v_mov_b32 v195, 0
v_mov_b32 v196, 0
v_mov_b32 v197, 0
v_mov_b32 v198, 0
v_mov_b32 v199, 0
v_mov_b32 v200, 0
v_mov_b32 v201, 0
v_mov_b32 v202, 0
v_mov_b32 v203, 0
v_mov_b32 v204, 0
v_mov_b32 v205, 0
v_mov_b32 v206, 0
v_mov_b32 v207, 0
v_mov_b32 v208, 0
v_mov_b32 v209, 0
v_mov_b32 v210, 0
v_mov_b32 v211, 0
v_mov_b32 v212, 0
v_mov_b32 v213, 0
v_mov_b32 v214, 0
v_mov_b32 v215, 0
v_mov_b32 v216, 0
v_mov_b32 v217, 0
v_mov_b32 v218, 0
v_mov_b32 v219, 0
v_mov_b32 v220, 0
v_mov_b32 v221, 0
v_mov_b32 v222, 0
v_mov_b32 v223, 0
v_mov_b32 v224, 0
v_mov_b32 v225, 0
v_mov_b32 v226, 0
v_mov_b32 v227, 0
v_mov_b32 v228, 0
v_mov_b32 v229, 0
v_mov_b32 v230, 0
v_mov_b32 v231, 0
v_mov_b32 v232, 0
v_mov_b32 v233, 0
v_mov_b32 v234, 0
v_mov_b32 v235, 0
v_mov_b32 v236, 0
v_mov_b32 v237, 0
v_mov_b32 v238, 0
v_mov_b32 v239, 0
v_mov_b32 v240, 0
v_mov_b32 v241, 0
v_mov_b32 v242, 0
v_mov_b32 v243, 0
v_mov_b32 v244, 0
v_mov_b32 v245, 0
v_mov_b32 v246, 0
v_mov_b32 v247, 0
v_mov_b32 v248, 0
v_mov_b32 v249, 0
v_mov_b32 v250, 0
v_mov_b32 v251, 0
v_mov_b32 v252, 0
v_mov_b32 v253, 0
v_mov_b32 v254, 0
v_mov_b32 v255, 0
v_mov_b32 v10, 0
v_mov_b32 v96, 0x7f7fffff
v_mov_b32 v11, 0
v_mov_b32 v100, 0x7f7fffff
v_mov_b32 v12, 0
v_mov_b32 v104, 0x7f7fffff
v_mov_b32 v13, 0
v_mov_b32 v108, 0x7f7fffff
s_mov_b32 s28, 0
L_fb_loop:
s_add_u32 m0, s31, 0
s_add_u32 s49, s28, 0
buffer_load_dwordx4 v60, s[12:15], s49 offen offset:0 nt lds
buffer_load_dwordx4 v61, s[12:15], s49 offen offset:1040 nt lds
buffer_load_dwordx4 v62, s[12:15], s49 offen offset:2080 nt lds
buffer_load_dwordx4 v63, s[12:15], s49 offen offset:3120 nt lds
s_add_u32 m0, s31, 4160
s_add_u32 s49, s28, 1024
buffer_load_dwordx4 v60, s[12:15], s49 offen offset:0 nt lds
buffer_load_dwordx4 v61, s[12:15], s49 offen offset:1040 nt lds
buffer_load_dwordx4 v62, s[12:15], s49 offen offset:2080 nt lds
buffer_load_dwordx4 v63, s[12:15], s49 offen offset:3120 nt lds
s_add_u32 m0, s31, 8320
s_add_u32 s49, s28, 2048
buffer_load_dwordx4 v60, s[12:15], s49 offen offset:0 nt lds
buffer_load_dwordx4 v61, s[12:15], s49 offen offset:1040 nt lds
buffer_load_dwordx4 v62, s[12:15], s49 offen offset:2080 nt lds
buffer_load_dwordx4 v63, s[12:15], s49 offen offset:3120 nt lds
s_add_u32 m0, s31, 12480
s_add_u32 s49, s28, 3072
buffer_load_dwordx4 v60, s[12:15], s49 offen offset:0 nt lds
buffer_load_dwordx4 v61, s[12:15], s49 offen offset:1040 nt lds
buffer_load_dwordx4 v62, s[12:15], s49 offen offset:2080 nt lds
buffer_load_dwordx4 v63, s[12:15], s49 offen offset:3120 nt lds
s_waitcnt vmcnt(0)
ds_read_b128 a[64:67], v2 offset:0
ds_read_b128 a[68:71], v2 offset:16
ds_read_b128 a[72:75], v2 offset:32
ds_read_b128 a[76:79], v2 offset:48
ds_read_b128 a[80:83], v2 offset:256
ds_read_b128 a[84:87], v2 offset:272
ds_read_b128 a[88:91], v2 offset:288
ds_read_b128 a[92:95], v2 offset:304
s_waitcnt lgkmcnt(0)
ds_read_b128 a[96:99], v2 offset:512
ds_read_b128 a[100:103], v2 offset:528
ds_read_b128 a[104:107], v2 offset:544
ds_read_b128 a[108:111], v2 offset:560
ds_read_b128 a[112:115], v2 offset:768
ds_read_b128 a[116:119], v2 offset:784
ds_read_b128 a[120:123], v2 offset:800
ds_read_b128 a[124:127], v2 offset:816
s_waitcnt lgkmcnt(0)
s_add_u32 m0, s31, 0
s_add_u32 s49, s28, 0
buffer_load_dwordx4 v60, s[16:19], s49 offen offset:0 nt lds
buffer_load_dwordx4 v61, s[16:19], s49 offen offset:1040 nt lds
buffer_load_dwordx4 v62, s[16:19], s49 offen offset:2080 nt lds
buffer_load_dwordx4 v63, s[16:19], s49 offen offset:3120 nt lds
s_add_u32 m0, s31, 4160
s_add_u32 s49, s28, 1024
buffer_load_dwordx4 v60, s[16:19], s49 offen offset:0 nt lds
buffer_load_dwordx4 v61, s[16:19], s49 offen offset:1040 nt lds
buffer_load_dwordx4 v62, s[16:19], s49 offen offset:2080 nt lds
buffer_load_dwordx4 v63, s[16:19], s49 offen offset:3120 nt lds
s_add_u32 m0, s31, 8320
s_add_u32 s49, s28, 2048
buffer_load_dwordx4 v60, s[16:19], s49 offen offset:0 nt lds
buffer_load_dwordx4 v61, s[16:19], s49 offen offset:1040 nt lds
buffer_load_dwordx4 v62, s[16:19], s49 offen offset:2080 nt lds
buffer_load_dwordx4 v63, s[16:19], s49 offen offset:3120 nt lds
s_add_u32 m0, s31, 12480
s_add_u32 s49, s28, 3072
buffer_load_dwordx4 v60, s[16:19], s49 offen offset:0 nt lds
buffer_load_dwordx4 v61, s[16:19], s49 offen offset:1040 nt lds
buffer_load_dwordx4 v62, s[16:19], s49 offen offset:2080 nt lds
buffer_load_dwordx4 v63, s[16:19], s49 offen offset:3120 nt lds
s_waitcnt vmcnt(0)
ds_read_b64_tr_b16 a[128:129], v4 offset:0
ds_read_b64_tr_b16 a[130:131], v4 offset:256
ds_read_b64_tr_b16 a[132:133], v4 offset:16
ds_read_b64_tr_b16 a[134:135], v4 offset:272
ds_read_b64_tr_b16 a[136:137], v4 offset:32
ds_read_b64_tr_b16 a[138:139], v4 offset:288
ds_read_b64_tr_b16 a[140:141], v4 offset:48
ds_read_b64_tr_b16 a[142:143], v4 offset:304
ds_read_b64_tr_b16 a[144:145], v4 offset:64
ds_read_b64_tr_b16 a[146:147], v4 offset:320
ds_read_b64_tr_b16 a[148:149], v4 offset:80
ds_read_b64_tr_b16 a[150:151], v4 offset:336
ds_read_b64_tr_b16 a[152:153], v4 offset:96
ds_read_b64_tr_b16 a[154:155], v4 offset:352
ds_read_b64_tr_b16 a[156:157], v4 offset:112
ds_read_b64_tr_b16 a[158:159], v4 offset:368
s_waitcnt lgkmcnt(0)
ds_read_b64_tr_b16 a[160:161], v4 offset:512
ds_read_b64_tr_b16 a[162:163], v4 offset:768
ds_read_b64_tr_b16 a[164:165], v4 offset:528
ds_read_b64_tr_b16 a[166:167], v4 offset:784
ds_read_b64_tr_b16 a[168:169], v4 offset:544
ds_read_b64_tr_b16 a[170:171], v4 offset:800
ds_read_b64_tr_b16 a[172:173], v4 offset:560
ds_read_b64_tr_b16 a[174:175], v4 offset:816
ds_read_b64_tr_b16 a[176:177], v4 offset:576
ds_read_b64_tr_b16 a[178:179], v4 offset:832
ds_read_b64_tr_b16 a[180:181], v4 offset:592
ds_read_b64_tr_b16 a[182:183], v4 offset:848
ds_read_b64_tr_b16 a[184:185], v4 offset:608
ds_read_b64_tr_b16 a[186:187], v4 offset:864
ds_read_b64_tr_b16 a[188:189], v4 offset:624
ds_read_b64_tr_b16 a[190:191], v4 offset:880
s_waitcnt lgkmcnt(0)
v_mfma_f32_16x16x32_bf16 v[64:67], a[64:67], a[0:3], 0
v_mfma_f32_16x16x32_bf16 v[64:67], a[68:71], a[4:7], v[64:67]
v_mfma_f32_16x16x32_bf16 v[64:67], a[72:75], a[8:11], v[64:67]
v_mfma_f32_16x16x32_bf16 v[64:67], a[76:79], a[12:15], v[64:67]
v_mfma_f32_16x16x32_bf16 v[68:71], a[80:83], a[0:3], 0
v_mfma_f32_16x16x32_bf16 v[68:71], a[84:87], a[4:7], v[68:71]
v_mfma_f32_16x16x32_bf16 v[68:71], a[88:91], a[8:11], v[68:71]
v_mfma_f32_16x16x32_bf16 v[68:71], a[92:95], a[12:15], v[68:71]
v_mfma_f32_16x16x32_bf16 v[72:75], a[64:67], a[16:19], 0
v_mfma_f32_16x16x32_bf16 v[72:75], a[68:71], a[20:23], v[72:75]
v_mfma_f32_16x16x32_bf16 v[72:75], a[72:75], a[24:27], v[72:75]
v_mfma_f32_16x16x32_bf16 v[72:75], a[76:79], a[28:31], v[72:75]
v_mfma_f32_16x16x32_bf16 v[76:79], a[80:83], a[16:19], 0
v_mfma_f32_16x16x32_bf16 v[76:79], a[84:87], a[20:23], v[76:79]
v_mfma_f32_16x16x32_bf16 v[76:79], a[88:91], a[24:27], v[76:79]
v_mfma_f32_16x16x32_bf16 v[76:79], a[92:95], a[28:31], v[76:79]
v_mfma_f32_16x16x32_bf16 v[80:83], a[64:67], a[32:35], 0
v_mfma_f32_16x16x32_bf16 v[80:83], a[68:71], a[36:39], v[80:83]
v_mfma_f32_16x16x32_bf16 v[80:83], a[72:75], a[40:43], v[80:83]
v_mfma_f32_16x16x32_bf16 v[80:83], a[76:79], a[44:47], v[80:83]
v_mfma_f32_16x16x32_bf16 v[84:87], a[80:83], a[32:35], 0
v_mfma_f32_16x16x32_bf16 v[84:87], a[84:87], a[36:39], v[84:87]
v_mfma_f32_16x16x32_bf16 v[84:87], a[88:91], a[40:43], v[84:87]
v_mfma_f32_16x16x32_bf16 v[84:87], a[92:95], a[44:47], v[84:87]
v_mfma_f32_16x16x32_bf16 v[88:91], a[64:67], a[48:51], 0
v_mfma_f32_16x16x32_bf16 v[88:91], a[68:71], a[52:55], v[88:91]
v_mfma_f32_16x16x32_bf16 v[88:91], a[72:75], a[56:59], v[88:91]
v_mfma_f32_16x16x32_bf16 v[88:91], a[76:79], a[60:63], v[88:91]
v_mfma_f32_16x16x32_bf16 v[92:95], a[80:83], a[48:51], 0
v_mfma_f32_16x16x32_bf16 v[92:95], a[84:87], a[52:55], v[92:95]
v_mfma_f32_16x16x32_bf16 v[92:95], a[88:91], a[56:59], v[92:95]
v_mfma_f32_16x16x32_bf16 v[92:95], a[92:95], a[60:63], v[92:95]
s_nop 15
v_max3_f32 v26, v64, v65, v66
v_max3_f32 v26, v26, v67, v68
v_max3_f32 v26, v26, v69, v70
v_max_f32 v26, v26, v71
v_mov_b32 v27, v26
s_nop 1
v_permlane32_swap_b32 v26, v27
v_max_f32 v26, v26, v27
v_mov_b32 v27, v26
s_nop 1
v_permlane16_swap_b32 v26, v27
v_max_f32 v26, v26, v27
v_sub_f32 v26, 0, v26
v_min_f32 v26, v26, v96
v_sub_f32 v27, v26, v96
v_exp_f32 v27, v27
v_mov_b32 v96, v26
v_mul_f32 v10, v10, v27
v_mul_f32 v128, v128, v27
v_mul_f32 v129, v129, v27
v_mul_f32 v130, v130, v27
v_mul_f32 v131, v131, v27
v_mul_f32 v132, v132, v27
v_mul_f32 v133, v133, v27
v_mul_f32 v134, v134, v27
v_mul_f32 v135, v135, v27
v_mul_f32 v136, v136, v27
v_mul_f32 v137, v137, v27
v_mul_f32 v138, v138, v27
v_mul_f32 v139, v139, v27
v_mul_f32 v140, v140, v27
v_mul_f32 v141, v141, v27
v_mul_f32 v142, v142, v27
v_mul_f32 v143, v143, v27
v_mul_f32 v144, v144, v27
v_mul_f32 v145, v145, v27
v_mul_f32 v146, v146, v27
v_mul_f32 v147, v147, v27
v_mul_f32 v148, v148, v27
v_mul_f32 v149, v149, v27
v_mul_f32 v150, v150, v27
v_mul_f32 v151, v151, v27
v_mul_f32 v152, v152, v27
v_mul_f32 v153, v153, v27
v_mul_f32 v154, v154, v27
v_mul_f32 v155, v155, v27
v_mul_f32 v156, v156, v27
v_mul_f32 v157, v157, v27
v_mul_f32 v158, v158, v27
v_mul_f32 v159, v159, v27
v_add_f32 v64, v64, v96
v_add_f32 v65, v65, v96
v_add_f32 v66, v66, v96
v_exp_f32 v64, v64
v_add_f32 v67, v67, v96
v_exp_f32 v65, v65
v_add_f32 v68, v68, v96
v_exp_f32 v66, v66
v_add_f32 v10, v10, v64
v_add_f32 v69, v69, v96
v_exp_f32 v67, v67
v_add_f32 v10, v10, v65
v_cvt_pk_bf16_f32 v64, v64, v65
v_add_f32 v70, v70, v96
v_exp_f32 v68, v68
v_add_f32 v10, v10, v66
v_add_f32 v71, v71, v96
v_exp_f32 v69, v69
v_add_f32 v10, v10, v67
v_cvt_pk_bf16_f32 v65, v66, v67
v_exp_f32 v70, v70
v_add_f32 v10, v10, v68
v_exp_f32 v71, v71
v_add_f32 v10, v10, v69
v_cvt_pk_bf16_f32 v66, v68, v69
v_add_f32 v10, v10, v70
v_add_f32 v10, v10, v71
v_cvt_pk_bf16_f32 v67, v70, v71
v_max3_f32 v26, v72, v73, v74
v_max3_f32 v26, v26, v75, v76
v_max3_f32 v26, v26, v77, v78
v_max_f32 v26, v26, v79
v_mov_b32 v27, v26
s_nop 1
v_permlane32_swap_b32 v26, v27
v_max_f32 v26, v26, v27
v_mov_b32 v27, v26
s_nop 1
v_permlane16_swap_b32 v26, v27
v_max_f32 v26, v26, v27
v_sub_f32 v26, 0, v26
v_min_f32 v26, v26, v100
v_sub_f32 v27, v26, v100
v_exp_f32 v27, v27
v_mov_b32 v100, v26
v_mul_f32 v11, v11, v27
v_mul_f32 v160, v160, v27
v_mul_f32 v161, v161, v27
v_mul_f32 v162, v162, v27
v_mul_f32 v163, v163, v27
v_mul_f32 v164, v164, v27
v_mul_f32 v165, v165, v27
v_mul_f32 v166, v166, v27
v_mul_f32 v167, v167, v27
v_mul_f32 v168, v168, v27
v_mul_f32 v169, v169, v27
v_mul_f32 v170, v170, v27
v_mul_f32 v171, v171, v27
v_mul_f32 v172, v172, v27
v_mul_f32 v173, v173, v27
v_mul_f32 v174, v174, v27
v_mul_f32 v175, v175, v27
v_mul_f32 v176, v176, v27
v_mul_f32 v177, v177, v27
v_mul_f32 v178, v178, v27
v_mul_f32 v179, v179, v27
v_mul_f32 v180, v180, v27
v_mul_f32 v181, v181, v27
v_mul_f32 v182, v182, v27
v_mul_f32 v183, v183, v27
v_mul_f32 v184, v184, v27
v_mul_f32 v185, v185, v27
v_mul_f32 v186, v186, v27
v_mul_f32 v187, v187, v27
v_mul_f32 v188, v188, v27
v_mul_f32 v189, v189, v27
v_mul_f32 v190, v190, v27
v_mul_f32 v191, v191, v27
v_add_f32 v72, v72, v100
v_add_f32 v73, v73, v100
v_add_f32 v74, v74, v100
v_exp_f32 v72, v72
v_add_f32 v75, v75, v100
v_exp_f32 v73, v73
v_add_f32 v76, v76, v100
v_exp_f32 v74, v74
v_add_f32 v11, v11, v72
v_add_f32 v77, v77, v100
v_exp_f32 v75, v75
v_add_f32 v11, v11, v73
v_cvt_pk_bf16_f32 v72, v72, v73
v_add_f32 v78, v78, v100
v_exp_f32 v76, v76
v_add_f32 v11, v11, v74
v_add_f32 v79, v79, v100
v_exp_f32 v77, v77
v_add_f32 v11, v11, v75
v_cvt_pk_bf16_f32 v73, v74, v75
v_exp_f32 v78, v78
v_add_f32 v11, v11, v76
v_exp_f32 v79, v79
v_add_f32 v11, v11, v77
v_cvt_pk_bf16_f32 v74, v76, v77
v_add_f32 v11, v11, v78
v_add_f32 v11, v11, v79
v_cvt_pk_bf16_f32 v75, v78, v79
v_max3_f32 v26, v80, v81, v82
v_max3_f32 v26, v26, v83, v84
v_max3_f32 v26, v26, v85, v86
v_max_f32 v26, v26, v87
v_mov_b32 v27, v26
s_nop 1
v_permlane32_swap_b32 v26, v27
v_max_f32 v26, v26, v27
v_mov_b32 v27, v26
s_nop 1
v_permlane16_swap_b32 v26, v27
v_max_f32 v26, v26, v27
v_sub_f32 v26, 0, v26
v_min_f32 v26, v26, v104
v_sub_f32 v27, v26, v104
v_exp_f32 v27, v27
v_mov_b32 v104, v26
v_mul_f32 v12, v12, v27
v_mul_f32 v192, v192, v27
v_mul_f32 v193, v193, v27
v_mul_f32 v194, v194, v27
v_mul_f32 v195, v195, v27
v_mul_f32 v196, v196, v27
v_mul_f32 v197, v197, v27
v_mul_f32 v198, v198, v27
v_mul_f32 v199, v199, v27
v_mul_f32 v200, v200, v27
v_mul_f32 v201, v201, v27
v_mul_f32 v202, v202, v27
v_mul_f32 v203, v203, v27
v_mul_f32 v204, v204, v27
v_mul_f32 v205, v205, v27
v_mul_f32 v206, v206, v27
v_mul_f32 v207, v207, v27
v_mul_f32 v208, v208, v27
v_mul_f32 v209, v209, v27
v_mul_f32 v210, v210, v27
v_mul_f32 v211, v211, v27
v_mul_f32 v212, v212, v27
v_mul_f32 v213, v213, v27
v_mul_f32 v214, v214, v27
v_mul_f32 v215, v215, v27
v_mul_f32 v216, v216, v27
v_mul_f32 v217, v217, v27
v_mul_f32 v218, v218, v27
v_mul_f32 v219, v219, v27
v_mul_f32 v220, v220, v27
v_mul_f32 v221, v221, v27
v_mul_f32 v222, v222, v27
v_mul_f32 v223, v223, v27
v_add_f32 v80, v80, v104
v_add_f32 v81, v81, v104
v_add_f32 v82, v82, v104
v_exp_f32 v80, v80
v_add_f32 v83, v83, v104
v_exp_f32 v81, v81
v_add_f32 v84, v84, v104
v_exp_f32 v82, v82
v_add_f32 v12, v12, v80
v_add_f32 v85, v85, v104
v_exp_f32 v83, v83
v_add_f32 v12, v12, v81
v_cvt_pk_bf16_f32 v80, v80, v81
v_add_f32 v86, v86, v104
v_exp_f32 v84, v84
v_add_f32 v12, v12, v82
v_add_f32 v87, v87, v104
v_exp_f32 v85, v85
v_add_f32 v12, v12, v83
v_cvt_pk_bf16_f32 v81, v82, v83
v_exp_f32 v86, v86
v_add_f32 v12, v12, v84
v_exp_f32 v87, v87
v_add_f32 v12, v12, v85
v_cvt_pk_bf16_f32 v82, v84, v85
v_add_f32 v12, v12, v86
v_add_f32 v12, v12, v87
v_cvt_pk_bf16_f32 v83, v86, v87
v_max3_f32 v26, v88, v89, v90
v_max3_f32 v26, v26, v91, v92
v_max3_f32 v26, v26, v93, v94
v_max_f32 v26, v26, v95
v_mov_b32 v27, v26
s_nop 1
v_permlane32_swap_b32 v26, v27
v_max_f32 v26, v26, v27
v_mov_b32 v27, v26
s_nop 1
v_permlane16_swap_b32 v26, v27
v_max_f32 v26, v26, v27
v_sub_f32 v26, 0, v26
v_min_f32 v26, v26, v108
v_sub_f32 v27, v26, v108
v_exp_f32 v27, v27
v_mov_b32 v108, v26
v_mul_f32 v13, v13, v27
v_mul_f32 v224, v224, v27
v_mul_f32 v225, v225, v27
v_mul_f32 v226, v226, v27
v_mul_f32 v227, v227, v27
v_mul_f32 v228, v228, v27
v_mul_f32 v229, v229, v27
v_mul_f32 v230, v230, v27
v_mul_f32 v231, v231, v27
v_mul_f32 v232, v232, v27
v_mul_f32 v233, v233, v27
v_mul_f32 v234, v234, v27
v_mul_f32 v235, v235, v27
v_mul_f32 v236, v236, v27
v_mul_f32 v237, v237, v27
v_mul_f32 v238, v238, v27
v_mul_f32 v239, v239, v27
v_mul_f32 v240, v240, v27
v_mul_f32 v241, v241, v27
v_mul_f32 v242, v242, v27
v_mul_f32 v243, v243, v27
v_mul_f32 v244, v244, v27
v_mul_f32 v245, v245, v27
v_mul_f32 v246, v246, v27
v_mul_f32 v247, v247, v27
v_mul_f32 v248, v248, v27
v_mul_f32 v249, v249, v27
v_mul_f32 v250, v250, v27
v_mul_f32 v251, v251, v27
v_mul_f32 v252, v252, v27
v_mul_f32 v253, v253, v27
v_mul_f32 v254, v254, v27
v_mul_f32 v255, v255, v27
v_add_f32 v88, v88, v108
v_add_f32 v89, v89, v108
v_add_f32 v90, v90, v108
v_exp_f32 v88, v88
v_add_f32 v91, v91, v108
v_exp_f32 v89, v89
v_add_f32 v92, v92, v108
v_exp_f32 v90, v90
v_add_f32 v13, v13, v88
v_add_f32 v93, v93, v108
v_exp_f32 v91, v91
v_add_f32 v13, v13, v89
v_cvt_pk_bf16_f32 v88, v88, v89
v_add_f32 v94, v94, v108
v_exp_f32 v92, v92
v_add_f32 v13, v13, v90
v_add_f32 v95, v95, v108
v_exp_f32 v93, v93
v_add_f32 v13, v13, v91
v_cvt_pk_bf16_f32 v89, v90, v91
v_exp_f32 v94, v94
v_add_f32 v13, v13, v92
v_exp_f32 v95, v95
v_add_f32 v13, v13, v93
v_cvt_pk_bf16_f32 v90, v92, v93
v_add_f32 v13, v13, v94
v_add_f32 v13, v13, v95
v_cvt_pk_bf16_f32 v91, v94, v95
s_nop 1
v_mfma_f32_16x16x32_bf16 v[128:131], a[128:131], v[64:67], v[128:131]
v_mfma_f32_16x16x32_bf16 v[132:135], a[132:135], v[64:67], v[132:135]
v_mfma_f32_16x16x32_bf16 v[136:139], a[136:139], v[64:67], v[136:139]
v_mfma_f32_16x16x32_bf16 v[140:143], a[140:143], v[64:67], v[140:143]
v_mfma_f32_16x16x32_bf16 v[144:147], a[144:147], v[64:67], v[144:147]
v_mfma_f32_16x16x32_bf16 v[148:151], a[148:151], v[64:67], v[148:151]
v_mfma_f32_16x16x32_bf16 v[152:155], a[152:155], v[64:67], v[152:155]
v_mfma_f32_16x16x32_bf16 v[156:159], a[156:159], v[64:67], v[156:159]
v_mfma_f32_16x16x32_bf16 v[160:163], a[128:131], v[72:75], v[160:163]
v_mfma_f32_16x16x32_bf16 v[164:167], a[132:135], v[72:75], v[164:167]
v_mfma_f32_16x16x32_bf16 v[168:171], a[136:139], v[72:75], v[168:171]
v_mfma_f32_16x16x32_bf16 v[172:175], a[140:143], v[72:75], v[172:175]
v_mfma_f32_16x16x32_bf16 v[176:179], a[144:147], v[72:75], v[176:179]
v_mfma_f32_16x16x32_bf16 v[180:183], a[148:151], v[72:75], v[180:183]
v_mfma_f32_16x16x32_bf16 v[184:187], a[152:155], v[72:75], v[184:187]
v_mfma_f32_16x16x32_bf16 v[188:191], a[156:159], v[72:75], v[188:191]
v_mfma_f32_16x16x32_bf16 v[192:195], a[128:131], v[80:83], v[192:195]
v_mfma_f32_16x16x32_bf16 v[196:199], a[132:135], v[80:83], v[196:199]
v_mfma_f32_16x16x32_bf16 v[200:203], a[136:139], v[80:83], v[200:203]
v_mfma_f32_16x16x32_bf16 v[204:207], a[140:143], v[80:83], v[204:207]
v_mfma_f32_16x16x32_bf16 v[208:211], a[144:147], v[80:83], v[208:211]
v_mfma_f32_16x16x32_bf16 v[212:215], a[148:151], v[80:83], v[212:215]
v_mfma_f32_16x16x32_bf16 v[216:219], a[152:155], v[80:83], v[216:219]
v_mfma_f32_16x16x32_bf16 v[220:223], a[156:159], v[80:83], v[220:223]
v_mfma_f32_16x16x32_bf16 v[224:227], a[128:131], v[88:91], v[224:227]
v_mfma_f32_16x16x32_bf16 v[228:231], a[132:135], v[88:91], v[228:231]
v_mfma_f32_16x16x32_bf16 v[232:235], a[136:139], v[88:91], v[232:235]
v_mfma_f32_16x16x32_bf16 v[236:239], a[140:143], v[88:91], v[236:239]
v_mfma_f32_16x16x32_bf16 v[240:243], a[144:147], v[88:91], v[240:243]
v_mfma_f32_16x16x32_bf16 v[244:247], a[148:151], v[88:91], v[244:247]
v_mfma_f32_16x16x32_bf16 v[248:251], a[152:155], v[88:91], v[248:251]
v_mfma_f32_16x16x32_bf16 v[252:255], a[156:159], v[88:91], v[252:255]
s_nop 15
v_mfma_f32_16x16x32_bf16 v[44:47], a[96:99], a[0:3], 0
v_mfma_f32_16x16x32_bf16 v[44:47], a[100:103], a[4:7], v[44:47]
v_mfma_f32_16x16x32_bf16 v[44:47], a[104:107], a[8:11], v[44:47]
v_mfma_f32_16x16x32_bf16 v[44:47], a[108:111], a[12:15], v[44:47]
v_mfma_f32_16x16x32_bf16 v[48:51], a[112:115], a[0:3], 0
v_mfma_f32_16x16x32_bf16 v[48:51], a[116:119], a[4:7], v[48:51]
v_mfma_f32_16x16x32_bf16 v[48:51], a[120:123], a[8:11], v[48:51]
v_mfma_f32_16x16x32_bf16 v[48:51], a[124:127], a[12:15], v[48:51]
v_mfma_f32_16x16x32_bf16 v[52:55], a[96:99], a[16:19], 0
v_mfma_f32_16x16x32_bf16 v[52:55], a[100:103], a[20:23], v[52:55]
v_mfma_f32_16x16x32_bf16 v[52:55], a[104:107], a[24:27], v[52:55]
v_mfma_f32_16x16x32_bf16 v[52:55], a[108:111], a[28:31], v[52:55]
v_mfma_f32_16x16x32_bf16 v[56:59], a[112:115], a[16:19], 0
v_mfma_f32_16x16x32_bf16 v[56:59], a[116:119], a[20:23], v[56:59]
v_mfma_f32_16x16x32_bf16 v[56:59], a[120:123], a[24:27], v[56:59]
v_mfma_f32_16x16x32_bf16 v[56:59], a[124:127], a[28:31], v[56:59]
v_mfma_f32_16x16x32_bf16 v[112:115], a[96:99], a[32:35], 0
v_mfma_f32_16x16x32_bf16 v[112:115], a[100:103], a[36:39], v[112:115]
v_mfma_f32_16x16x32_bf16 v[112:115], a[104:107], a[40:43], v[112:115]
v_mfma_f32_16x16x32_bf16 v[112:115], a[108:111], a[44:47], v[112:115]
v_mfma_f32_16x16x32_bf16 v[116:119], a[112:115], a[32:35], 0
v_mfma_f32_16x16x32_bf16 v[116:119], a[116:119], a[36:39], v[116:119]
v_mfma_f32_16x16x32_bf16 v[116:119], a[120:123], a[40:43], v[116:119]
v_mfma_f32_16x16x32_bf16 v[116:119], a[124:127], a[44:47], v[116:119]
v_mfma_f32_16x16x32_bf16 v[120:123], a[96:99], a[48:51], 0
v_mfma_f32_16x16x32_bf16 v[120:123], a[100:103], a[52:55], v[120:123]
v_mfma_f32_16x16x32_bf16 v[120:123], a[104:107], a[56:59], v[120:123]
v_mfma_f32_16x16x32_bf16 v[120:123], a[108:111], a[60:63], v[120:123]
v_mfma_f32_16x16x32_bf16 v[124:127], a[112:115], a[48:51], 0
v_mfma_f32_16x16x32_bf16 v[124:127], a[116:119], a[52:55], v[124:127]
v_mfma_f32_16x16x32_bf16 v[124:127], a[120:123], a[56:59], v[124:127]
v_mfma_f32_16x16x32_bf16 v[124:127], a[124:127], a[60:63], v[124:127]
s_nop 15
v_max3_f32 v26, v44, v45, v46
v_max3_f32 v26, v26, v47, v48
v_max3_f32 v26, v26, v49, v50
v_max_f32 v26, v26, v51
v_mov_b32 v27, v26
s_nop 1
v_permlane32_swap_b32 v26, v27
v_max_f32 v26, v26, v27
v_mov_b32 v27, v26
s_nop 1
v_permlane16_swap_b32 v26, v27
v_max_f32 v26, v26, v27
v_sub_f32 v26, 0, v26
v_min_f32 v26, v26, v96
v_sub_f32 v27, v26, v96
v_exp_f32 v27, v27
v_mov_b32 v96, v26
v_mul_f32 v10, v10, v27
v_mul_f32 v128, v128, v27
v_mul_f32 v129, v129, v27
v_mul_f32 v130, v130, v27
v_mul_f32 v131, v131, v27
v_mul_f32 v132, v132, v27
v_mul_f32 v133, v133, v27
v_mul_f32 v134, v134, v27
v_mul_f32 v135, v135, v27
v_mul_f32 v136, v136, v27
v_mul_f32 v137, v137, v27
v_mul_f32 v138, v138, v27
v_mul_f32 v139, v139, v27
v_mul_f32 v140, v140, v27
v_mul_f32 v141, v141, v27
v_mul_f32 v142, v142, v27
v_mul_f32 v143, v143, v27
v_mul_f32 v144, v144, v27
v_mul_f32 v145, v145, v27
v_mul_f32 v146, v146, v27
v_mul_f32 v147, v147, v27
v_mul_f32 v148, v148, v27
v_mul_f32 v149, v149, v27
v_mul_f32 v150, v150, v27
v_mul_f32 v151, v151, v27
v_mul_f32 v152, v152, v27
v_mul_f32 v153, v153, v27
v_mul_f32 v154, v154, v27
v_mul_f32 v155, v155, v27
v_mul_f32 v156, v156, v27
v_mul_f32 v157, v157, v27
v_mul_f32 v158, v158, v27
v_mul_f32 v159, v159, v27
v_add_f32 v44, v44, v96
v_add_f32 v45, v45, v96
v_add_f32 v46, v46, v96
v_exp_f32 v44, v44
v_add_f32 v47, v47, v96
v_exp_f32 v45, v45
v_add_f32 v48, v48, v96
v_exp_f32 v46, v46
v_add_f32 v10, v10, v44
v_add_f32 v49, v49, v96
v_exp_f32 v47, v47
v_add_f32 v10, v10, v45
v_cvt_pk_bf16_f32 v44, v44, v45
v_add_f32 v50, v50, v96
v_exp_f32 v48, v48
v_add_f32 v10, v10, v46
v_add_f32 v51, v51, v96
v_exp_f32 v49, v49
v_add_f32 v10, v10, v47
v_cvt_pk_bf16_f32 v45, v46, v47
v_exp_f32 v50, v50
v_add_f32 v10, v10, v48
v_exp_f32 v51, v51
v_add_f32 v10, v10, v49
v_cvt_pk_bf16_f32 v46, v48, v49
v_add_f32 v10, v10, v50
v_add_f32 v10, v10, v51
v_cvt_pk_bf16_f32 v47, v50, v51
v_max3_f32 v26, v52, v53, v54
v_max3_f32 v26, v26, v55, v56
v_max3_f32 v26, v26, v57, v58
v_max_f32 v26, v26, v59
v_mov_b32 v27, v26
s_nop 1
v_permlane32_swap_b32 v26, v27
v_max_f32 v26, v26, v27
v_mov_b32 v27, v26
s_nop 1
v_permlane16_swap_b32 v26, v27
v_max_f32 v26, v26, v27
v_sub_f32 v26, 0, v26
v_min_f32 v26, v26, v100
v_sub_f32 v27, v26, v100
v_exp_f32 v27, v27
v_mov_b32 v100, v26
v_mul_f32 v11, v11, v27
v_mul_f32 v160, v160, v27
v_mul_f32 v161, v161, v27
v_mul_f32 v162, v162, v27
v_mul_f32 v163, v163, v27
v_mul_f32 v164, v164, v27
v_mul_f32 v165, v165, v27
v_mul_f32 v166, v166, v27
v_mul_f32 v167, v167, v27
v_mul_f32 v168, v168, v27
v_mul_f32 v169, v169, v27
v_mul_f32 v170, v170, v27
v_mul_f32 v171, v171, v27
v_mul_f32 v172, v172, v27
v_mul_f32 v173, v173, v27
v_mul_f32 v174, v174, v27
v_mul_f32 v175, v175, v27
v_mul_f32 v176, v176, v27
v_mul_f32 v177, v177, v27
v_mul_f32 v178, v178, v27
v_mul_f32 v179, v179, v27
v_mul_f32 v180, v180, v27
v_mul_f32 v181, v181, v27
v_mul_f32 v182, v182, v27
v_mul_f32 v183, v183, v27
v_mul_f32 v184, v184, v27
v_mul_f32 v185, v185, v27
v_mul_f32 v186, v186, v27
v_mul_f32 v187, v187, v27
v_mul_f32 v188, v188, v27
v_mul_f32 v189, v189, v27
v_mul_f32 v190, v190, v27
v_mul_f32 v191, v191, v27
v_add_f32 v52, v52, v100
v_add_f32 v53, v53, v100
v_add_f32 v54, v54, v100
v_exp_f32 v52, v52
v_add_f32 v55, v55, v100
v_exp_f32 v53, v53
v_add_f32 v56, v56, v100
v_exp_f32 v54, v54
v_add_f32 v11, v11, v52
v_add_f32 v57, v57, v100
v_exp_f32 v55, v55
v_add_f32 v11, v11, v53
v_cvt_pk_bf16_f32 v52, v52, v53
v_add_f32 v58, v58, v100
v_exp_f32 v56, v56
v_add_f32 v11, v11, v54
v_add_f32 v59, v59, v100
v_exp_f32 v57, v57
v_add_f32 v11, v11, v55
v_cvt_pk_bf16_f32 v53, v54, v55
v_exp_f32 v58, v58
v_add_f32 v11, v11, v56
v_exp_f32 v59, v59
v_add_f32 v11, v11, v57
v_cvt_pk_bf16_f32 v54, v56, v57
v_add_f32 v11, v11, v58
v_add_f32 v11, v11, v59
v_cvt_pk_bf16_f32 v55, v58, v59
v_max3_f32 v26, v112, v113, v114
v_max3_f32 v26, v26, v115, v116
v_max3_f32 v26, v26, v117, v118
v_max_f32 v26, v26, v119
v_mov_b32 v27, v26
s_nop 1
v_permlane32_swap_b32 v26, v27
v_max_f32 v26, v26, v27
v_mov_b32 v27, v26
s_nop 1
v_permlane16_swap_b32 v26, v27
v_max_f32 v26, v26, v27
v_sub_f32 v26, 0, v26
v_min_f32 v26, v26, v104
v_sub_f32 v27, v26, v104
v_exp_f32 v27, v27
v_mov_b32 v104, v26
v_mul_f32 v12, v12, v27
v_mul_f32 v192, v192, v27
v_mul_f32 v193, v193, v27
v_mul_f32 v194, v194, v27
v_mul_f32 v195, v195, v27
v_mul_f32 v196, v196, v27
v_mul_f32 v197, v197, v27
v_mul_f32 v198, v198, v27
v_mul_f32 v199, v199, v27
v_mul_f32 v200, v200, v27
v_mul_f32 v201, v201, v27
v_mul_f32 v202, v202, v27
v_mul_f32 v203, v203, v27
v_mul_f32 v204, v204, v27
v_mul_f32 v205, v205, v27
v_mul_f32 v206, v206, v27
v_mul_f32 v207, v207, v27
v_mul_f32 v208, v208, v27
v_mul_f32 v209, v209, v27
v_mul_f32 v210, v210, v27
v_mul_f32 v211, v211, v27
v_mul_f32 v212, v212, v27
v_mul_f32 v213, v213, v27
v_mul_f32 v214, v214, v27
v_mul_f32 v215, v215, v27
v_mul_f32 v216, v216, v27
v_mul_f32 v217, v217, v27
v_mul_f32 v218, v218, v27
v_mul_f32 v219, v219, v27
v_mul_f32 v220, v220, v27
v_mul_f32 v221, v221, v27
v_mul_f32 v222, v222, v27
v_mul_f32 v223, v223, v27
v_add_f32 v112, v112, v104
v_add_f32 v113, v113, v104
v_add_f32 v114, v114, v104
v_exp_f32 v112, v112
v_add_f32 v115, v115, v104
v_exp_f32 v113, v113
v_add_f32 v116, v116, v104
v_exp_f32 v114, v114
v_add_f32 v12, v12, v112
v_add_f32 v117, v117, v104
v_exp_f32 v115, v115
v_add_f32 v12, v12, v113
v_cvt_pk_bf16_f32 v112, v112, v113
v_add_f32 v118, v118, v104
v_exp_f32 v116, v116
v_add_f32 v12, v12, v114
v_add_f32 v119, v119, v104
v_exp_f32 v117, v117
v_add_f32 v12, v12, v115
v_cvt_pk_bf16_f32 v113, v114, v115
v_exp_f32 v118, v118
v_add_f32 v12, v12, v116
v_exp_f32 v119, v119
v_add_f32 v12, v12, v117
v_cvt_pk_bf16_f32 v114, v116, v117
v_add_f32 v12, v12, v118
v_add_f32 v12, v12, v119
v_cvt_pk_bf16_f32 v115, v118, v119
v_max3_f32 v26, v120, v121, v122
v_max3_f32 v26, v26, v123, v124
v_max3_f32 v26, v26, v125, v126
v_max_f32 v26, v26, v127
v_mov_b32 v27, v26
s_nop 1
v_permlane32_swap_b32 v26, v27
v_max_f32 v26, v26, v27
v_mov_b32 v27, v26
s_nop 1
v_permlane16_swap_b32 v26, v27
v_max_f32 v26, v26, v27
v_sub_f32 v26, 0, v26
v_min_f32 v26, v26, v108
v_sub_f32 v27, v26, v108
v_exp_f32 v27, v27
v_mov_b32 v108, v26
v_mul_f32 v13, v13, v27
v_mul_f32 v224, v224, v27
v_mul_f32 v225, v225, v27
v_mul_f32 v226, v226, v27
v_mul_f32 v227, v227, v27
v_mul_f32 v228, v228, v27
v_mul_f32 v229, v229, v27
v_mul_f32 v230, v230, v27
v_mul_f32 v231, v231, v27
v_mul_f32 v232, v232, v27
v_mul_f32 v233, v233, v27
v_mul_f32 v234, v234, v27
v_mul_f32 v235, v235, v27
v_mul_f32 v236, v236, v27
v_mul_f32 v237, v237, v27
v_mul_f32 v238, v238, v27
v_mul_f32 v239, v239, v27
v_mul_f32 v240, v240, v27
v_mul_f32 v241, v241, v27
v_mul_f32 v242, v242, v27
v_mul_f32 v243, v243, v27
v_mul_f32 v244, v244, v27
v_mul_f32 v245, v245, v27
v_mul_f32 v246, v246, v27
v_mul_f32 v247, v247, v27
v_mul_f32 v248, v248, v27
v_mul_f32 v249, v249, v27
v_mul_f32 v250, v250, v27
v_mul_f32 v251, v251, v27
v_mul_f32 v252, v252, v27
v_mul_f32 v253, v253, v27
v_mul_f32 v254, v254, v27
v_mul_f32 v255, v255, v27
v_add_f32 v120, v120, v108
v_add_f32 v121, v121, v108
v_add_f32 v122, v122, v108
v_exp_f32 v120, v120
v_add_f32 v123, v123, v108
v_exp_f32 v121, v121
v_add_f32 v124, v124, v108
v_exp_f32 v122, v122
v_add_f32 v13, v13, v120
v_add_f32 v125, v125, v108
v_exp_f32 v123, v123
v_add_f32 v13, v13, v121
v_cvt_pk_bf16_f32 v120, v120, v121
v_add_f32 v126, v126, v108
v_exp_f32 v124, v124
v_add_f32 v13, v13, v122
v_add_f32 v127, v127, v108
v_exp_f32 v125, v125
v_add_f32 v13, v13, v123
v_cvt_pk_bf16_f32 v121, v122, v123
v_exp_f32 v126, v126
v_add_f32 v13, v13, v124
v_exp_f32 v127, v127
v_add_f32 v13, v13, v125
v_cvt_pk_bf16_f32 v122, v124, v125
v_add_f32 v13, v13, v126
v_add_f32 v13, v13, v127
v_cvt_pk_bf16_f32 v123, v126, v127
s_nop 1
v_mfma_f32_16x16x32_bf16 v[128:131], a[160:163], v[44:47], v[128:131]
v_mfma_f32_16x16x32_bf16 v[132:135], a[164:167], v[44:47], v[132:135]
v_mfma_f32_16x16x32_bf16 v[136:139], a[168:171], v[44:47], v[136:139]
v_mfma_f32_16x16x32_bf16 v[140:143], a[172:175], v[44:47], v[140:143]
v_mfma_f32_16x16x32_bf16 v[144:147], a[176:179], v[44:47], v[144:147]
v_mfma_f32_16x16x32_bf16 v[148:151], a[180:183], v[44:47], v[148:151]
v_mfma_f32_16x16x32_bf16 v[152:155], a[184:187], v[44:47], v[152:155]
v_mfma_f32_16x16x32_bf16 v[156:159], a[188:191], v[44:47], v[156:159]
v_mfma_f32_16x16x32_bf16 v[160:163], a[160:163], v[52:55], v[160:163]
v_mfma_f32_16x16x32_bf16 v[164:167], a[164:167], v[52:55], v[164:167]
v_mfma_f32_16x16x32_bf16 v[168:171], a[168:171], v[52:55], v[168:171]
v_mfma_f32_16x16x32_bf16 v[172:175], a[172:175], v[52:55], v[172:175]
v_mfma_f32_16x16x32_bf16 v[176:179], a[176:179], v[52:55], v[176:179]
v_mfma_f32_16x16x32_bf16 v[180:183], a[180:183], v[52:55], v[180:183]
v_mfma_f32_16x16x32_bf16 v[184:187], a[184:187], v[52:55], v[184:187]
v_mfma_f32_16x16x32_bf16 v[188:191], a[188:191], v[52:55], v[188:191]
v_mfma_f32_16x16x32_bf16 v[192:195], a[160:163], v[112:115], v[192:195]
v_mfma_f32_16x16x32_bf16 v[196:199], a[164:167], v[112:115], v[196:199]
v_mfma_f32_16x16x32_bf16 v[200:203], a[168:171], v[112:115], v[200:203]
v_mfma_f32_16x16x32_bf16 v[204:207], a[172:175], v[112:115], v[204:207]
v_mfma_f32_16x16x32_bf16 v[208:211], a[176:179], v[112:115], v[208:211]
v_mfma_f32_16x16x32_bf16 v[212:215], a[180:183], v[112:115], v[212:215]
v_mfma_f32_16x16x32_bf16 v[216:219], a[184:187], v[112:115], v[216:219]
v_mfma_f32_16x16x32_bf16 v[220:223], a[188:191], v[112:115], v[220:223]
v_mfma_f32_16x16x32_bf16 v[224:227], a[160:163], v[120:123], v[224:227]
v_mfma_f32_16x16x32_bf16 v[228:231], a[164:167], v[120:123], v[228:231]
v_mfma_f32_16x16x32_bf16 v[232:235], a[168:171], v[120:123], v[232:235]
v_mfma_f32_16x16x32_bf16 v[236:239], a[172:175], v[120:123], v[236:239]
v_mfma_f32_16x16x32_bf16 v[240:243], a[176:179], v[120:123], v[240:243]
v_mfma_f32_16x16x32_bf16 v[244:247], a[180:183], v[120:123], v[244:247]
v_mfma_f32_16x16x32_bf16 v[248:251], a[184:187], v[120:123], v[248:251]
v_mfma_f32_16x16x32_bf16 v[252:255], a[188:191], v[120:123], v[252:255]
s_nop 15
s_add_u32 s28, s28, 16384
s_cmp_lt_u32 s28, 262144
s_cbranch_scc1 L_fb_loop
v_mov_b32 v18, v10
s_nop 1
v_permlane32_swap_b32 v10, v18
v_add_f32 v10, v10, v18
v_mov_b32 v18, v10
s_nop 1
v_permlane16_swap_b32 v10, v18
v_add_f32 v10, v10, v18
v_rcp_f32 v18, v10
s_nop 0
v_mul_f32 v128, v128, v18
v_mul_f32 v129, v129, v18
v_mul_f32 v130, v130, v18
v_mul_f32 v131, v131, v18
v_cvt_pk_bf16_f32 v128, v128, v129
v_cvt_pk_bf16_f32 v129, v130, v131
ds_write_b64 v15, v[128:129] offset:0
v_mul_f32 v132, v132, v18
v_mul_f32 v133, v133, v18
v_mul_f32 v134, v134, v18
v_mul_f32 v135, v135, v18
v_cvt_pk_bf16_f32 v132, v132, v133
v_cvt_pk_bf16_f32 v133, v134, v135
ds_write_b64 v15, v[132:133] offset:16
v_mul_f32 v136, v136, v18
v_mul_f32 v137, v137, v18
v_mul_f32 v138, v138, v18
v_mul_f32 v139, v139, v18
v_cvt_pk_bf16_f32 v136, v136, v137
v_cvt_pk_bf16_f32 v137, v138, v139
ds_write_b64 v15, v[136:137] offset:32
v_mul_f32 v140, v140, v18
v_mul_f32 v141, v141, v18
v_mul_f32 v142, v142, v18
v_mul_f32 v143, v143, v18
v_cvt_pk_bf16_f32 v140, v140, v141
v_cvt_pk_bf16_f32 v141, v142, v143
ds_write_b64 v15, v[140:141] offset:48
v_mul_f32 v144, v144, v18
v_mul_f32 v145, v145, v18
v_mul_f32 v146, v146, v18
v_mul_f32 v147, v147, v18
v_cvt_pk_bf16_f32 v144, v144, v145
v_cvt_pk_bf16_f32 v145, v146, v147
ds_write_b64 v15, v[144:145] offset:64
v_mul_f32 v148, v148, v18
v_mul_f32 v149, v149, v18
v_mul_f32 v150, v150, v18
v_mul_f32 v151, v151, v18
v_cvt_pk_bf16_f32 v148, v148, v149
v_cvt_pk_bf16_f32 v149, v150, v151
ds_write_b64 v15, v[148:149] offset:80
v_mul_f32 v152, v152, v18
v_mul_f32 v153, v153, v18
v_mul_f32 v154, v154, v18
v_mul_f32 v155, v155, v18
v_cvt_pk_bf16_f32 v152, v152, v153
v_cvt_pk_bf16_f32 v153, v154, v155
ds_write_b64 v15, v[152:153] offset:96
v_mul_f32 v156, v156, v18
v_mul_f32 v157, v157, v18
v_mul_f32 v158, v158, v18
v_mul_f32 v159, v159, v18
v_cvt_pk_bf16_f32 v156, v156, v157
v_cvt_pk_bf16_f32 v157, v158, v159
ds_write_b64 v15, v[156:157] offset:112
s_waitcnt lgkmcnt(0)
ds_read_b128 v[128:131], v16 offset:0
ds_read_b128 v[132:135], v16 offset:1088
ds_read_b128 v[136:139], v16 offset:2176
ds_read_b128 v[140:143], v16 offset:3264
s_waitcnt lgkmcnt(0)
buffer_store_dwordx4 v[128:131], v6, s[20:23], 0 offen offset:0 sc0 sc1
buffer_store_dwordx4 v[132:135], v7, s[20:23], 0 offen offset:1040 sc0 sc1
buffer_store_dwordx4 v[136:139], v8, s[20:23], 0 offen offset:2080 sc0 sc1
buffer_store_dwordx4 v[140:143], v9, s[20:23], 0 offen offset:3120 sc0 sc1
v_mov_b32 v20, v11
s_nop 1
v_permlane32_swap_b32 v11, v20
v_add_f32 v11, v11, v20
v_mov_b32 v20, v11
s_nop 1
v_permlane16_swap_b32 v11, v20
v_add_f32 v11, v11, v20
v_rcp_f32 v20, v11
s_nop 0
v_mul_f32 v160, v160, v20
v_mul_f32 v161, v161, v20
v_mul_f32 v162, v162, v20
v_mul_f32 v163, v163, v20
v_cvt_pk_bf16_f32 v160, v160, v161
v_cvt_pk_bf16_f32 v161, v162, v163
ds_write_b64 v15, v[160:161] offset:4352
v_mul_f32 v164, v164, v20
v_mul_f32 v165, v165, v20
v_mul_f32 v166, v166, v20
v_mul_f32 v167, v167, v20
v_cvt_pk_bf16_f32 v164, v164, v165
v_cvt_pk_bf16_f32 v165, v166, v167
ds_write_b64 v15, v[164:165] offset:4368
v_mul_f32 v168, v168, v20
v_mul_f32 v169, v169, v20
v_mul_f32 v170, v170, v20
v_mul_f32 v171, v171, v20
v_cvt_pk_bf16_f32 v168, v168, v169
v_cvt_pk_bf16_f32 v169, v170, v171
ds_write_b64 v15, v[168:169] offset:4384
v_mul_f32 v172, v172, v20
v_mul_f32 v173, v173, v20
v_mul_f32 v174, v174, v20
v_mul_f32 v175, v175, v20
v_cvt_pk_bf16_f32 v172, v172, v173
v_cvt_pk_bf16_f32 v173, v174, v175
ds_write_b64 v15, v[172:173] offset:4400
v_mul_f32 v176, v176, v20
v_mul_f32 v177, v177, v20
v_mul_f32 v178, v178, v20
v_mul_f32 v179, v179, v20
v_cvt_pk_bf16_f32 v176, v176, v177
v_cvt_pk_bf16_f32 v177, v178, v179
ds_write_b64 v15, v[176:177] offset:4416
v_mul_f32 v180, v180, v20
v_mul_f32 v181, v181, v20
v_mul_f32 v182, v182, v20
v_mul_f32 v183, v183, v20
v_cvt_pk_bf16_f32 v180, v180, v181
v_cvt_pk_bf16_f32 v181, v182, v183
ds_write_b64 v15, v[180:181] offset:4432
v_mul_f32 v184, v184, v20
v_mul_f32 v185, v185, v20
v_mul_f32 v186, v186, v20
v_mul_f32 v187, v187, v20
v_cvt_pk_bf16_f32 v184, v184, v185
v_cvt_pk_bf16_f32 v185, v186, v187
ds_write_b64 v15, v[184:185] offset:4448
v_mul_f32 v188, v188, v20
v_mul_f32 v189, v189, v20
v_mul_f32 v190, v190, v20
v_mul_f32 v191, v191, v20
v_cvt_pk_bf16_f32 v188, v188, v189
v_cvt_pk_bf16_f32 v189, v190, v191
ds_write_b64 v15, v[188:189] offset:4464
s_waitcnt lgkmcnt(0)
ds_read_b128 v[160:163], v16 offset:4352
ds_read_b128 v[164:167], v16 offset:5440
ds_read_b128 v[168:171], v16 offset:6528
ds_read_b128 v[172:175], v16 offset:7616
s_waitcnt lgkmcnt(0)
buffer_store_dwordx4 v[160:163], v6, s[20:23], s32 offen offset:0 sc0 sc1
buffer_store_dwordx4 v[164:167], v7, s[20:23], s32 offen offset:1040 sc0 sc1
buffer_store_dwordx4 v[168:171], v8, s[20:23], s32 offen offset:2080 sc0 sc1
buffer_store_dwordx4 v[172:175], v9, s[20:23], s32 offen offset:3120 sc0 sc1
v_mov_b32 v22, v12
s_nop 1
v_permlane32_swap_b32 v12, v22
v_add_f32 v12, v12, v22
v_mov_b32 v22, v12
s_nop 1
v_permlane16_swap_b32 v12, v22
v_add_f32 v12, v12, v22
v_rcp_f32 v22, v12
s_nop 0
v_mul_f32 v192, v192, v22
v_mul_f32 v193, v193, v22
v_mul_f32 v194, v194, v22
v_mul_f32 v195, v195, v22
v_cvt_pk_bf16_f32 v192, v192, v193
v_cvt_pk_bf16_f32 v193, v194, v195
ds_write_b64 v15, v[192:193] offset:8704
v_mul_f32 v196, v196, v22
v_mul_f32 v197, v197, v22
v_mul_f32 v198, v198, v22
v_mul_f32 v199, v199, v22
v_cvt_pk_bf16_f32 v196, v196, v197
v_cvt_pk_bf16_f32 v197, v198, v199
ds_write_b64 v15, v[196:197] offset:8720
v_mul_f32 v200, v200, v22
v_mul_f32 v201, v201, v22
v_mul_f32 v202, v202, v22
v_mul_f32 v203, v203, v22
v_cvt_pk_bf16_f32 v200, v200, v201
v_cvt_pk_bf16_f32 v201, v202, v203
ds_write_b64 v15, v[200:201] offset:8736
v_mul_f32 v204, v204, v22
v_mul_f32 v205, v205, v22
v_mul_f32 v206, v206, v22
v_mul_f32 v207, v207, v22
v_cvt_pk_bf16_f32 v204, v204, v205
v_cvt_pk_bf16_f32 v205, v206, v207
ds_write_b64 v15, v[204:205] offset:8752
v_mul_f32 v208, v208, v22
v_mul_f32 v209, v209, v22
v_mul_f32 v210, v210, v22
v_mul_f32 v211, v211, v22
v_cvt_pk_bf16_f32 v208, v208, v209
v_cvt_pk_bf16_f32 v209, v210, v211
ds_write_b64 v15, v[208:209] offset:8768
v_mul_f32 v212, v212, v22
v_mul_f32 v213, v213, v22
v_mul_f32 v214, v214, v22
v_mul_f32 v215, v215, v22
v_cvt_pk_bf16_f32 v212, v212, v213
v_cvt_pk_bf16_f32 v213, v214, v215
ds_write_b64 v15, v[212:213] offset:8784
v_mul_f32 v216, v216, v22
v_mul_f32 v217, v217, v22
v_mul_f32 v218, v218, v22
v_mul_f32 v219, v219, v22
v_cvt_pk_bf16_f32 v216, v216, v217
v_cvt_pk_bf16_f32 v217, v218, v219
ds_write_b64 v15, v[216:217] offset:8800
v_mul_f32 v220, v220, v22
v_mul_f32 v221, v221, v22
v_mul_f32 v222, v222, v22
v_mul_f32 v223, v223, v22
v_cvt_pk_bf16_f32 v220, v220, v221
v_cvt_pk_bf16_f32 v221, v222, v223
ds_write_b64 v15, v[220:221] offset:8816
s_waitcnt lgkmcnt(0)
ds_read_b128 v[192:195], v16 offset:8704
ds_read_b128 v[196:199], v16 offset:9792
ds_read_b128 v[200:203], v16 offset:10880
ds_read_b128 v[204:207], v16 offset:11968
s_waitcnt lgkmcnt(0)
buffer_store_dwordx4 v[192:195], v6, s[20:23], s33 offen offset:0 sc0 sc1
buffer_store_dwordx4 v[196:199], v7, s[20:23], s33 offen offset:1040 sc0 sc1
buffer_store_dwordx4 v[200:203], v8, s[20:23], s33 offen offset:2080 sc0 sc1
buffer_store_dwordx4 v[204:207], v9, s[20:23], s33 offen offset:3120 sc0 sc1
v_mov_b32 v24, v13
s_nop 1
v_permlane32_swap_b32 v13, v24
v_add_f32 v13, v13, v24
v_mov_b32 v24, v13
s_nop 1
v_permlane16_swap_b32 v13, v24
v_add_f32 v13, v13, v24
v_rcp_f32 v24, v13
s_nop 0
v_mul_f32 v224, v224, v24
v_mul_f32 v225, v225, v24
v_mul_f32 v226, v226, v24
v_mul_f32 v227, v227, v24
v_cvt_pk_bf16_f32 v224, v224, v225
v_cvt_pk_bf16_f32 v225, v226, v227
ds_write_b64 v15, v[224:225] offset:13056
v_mul_f32 v228, v228, v24
v_mul_f32 v229, v229, v24
v_mul_f32 v230, v230, v24
v_mul_f32 v231, v231, v24
v_cvt_pk_bf16_f32 v228, v228, v229
v_cvt_pk_bf16_f32 v229, v230, v231
ds_write_b64 v15, v[228:229] offset:13072
v_mul_f32 v232, v232, v24
v_mul_f32 v233, v233, v24
v_mul_f32 v234, v234, v24
v_mul_f32 v235, v235, v24
v_cvt_pk_bf16_f32 v232, v232, v233
v_cvt_pk_bf16_f32 v233, v234, v235
ds_write_b64 v15, v[232:233] offset:13088
v_mul_f32 v236, v236, v24
v_mul_f32 v237, v237, v24
v_mul_f32 v238, v238, v24
v_mul_f32 v239, v239, v24
v_cvt_pk_bf16_f32 v236, v236, v237
v_cvt_pk_bf16_f32 v237, v238, v239
ds_write_b64 v15, v[236:237] offset:13104
v_mul_f32 v240, v240, v24
v_mul_f32 v241, v241, v24
v_mul_f32 v242, v242, v24
v_mul_f32 v243, v243, v24
v_cvt_pk_bf16_f32 v240, v240, v241
v_cvt_pk_bf16_f32 v241, v242, v243
ds_write_b64 v15, v[240:241] offset:13120
v_mul_f32 v244, v244, v24
v_mul_f32 v245, v245, v24
v_mul_f32 v246, v246, v24
v_mul_f32 v247, v247, v24
v_cvt_pk_bf16_f32 v244, v244, v245
v_cvt_pk_bf16_f32 v245, v246, v247
ds_write_b64 v15, v[244:245] offset:13136
v_mul_f32 v248, v248, v24
v_mul_f32 v249, v249, v24
v_mul_f32 v250, v250, v24
v_mul_f32 v251, v251, v24
v_cvt_pk_bf16_f32 v248, v248, v249
v_cvt_pk_bf16_f32 v249, v250, v251
ds_write_b64 v15, v[248:249] offset:13152
v_mul_f32 v252, v252, v24
v_mul_f32 v253, v253, v24
v_mul_f32 v254, v254, v24
v_mul_f32 v255, v255, v24
v_cvt_pk_bf16_f32 v252, v252, v253
v_cvt_pk_bf16_f32 v253, v254, v255
ds_write_b64 v15, v[252:253] offset:13168
s_waitcnt lgkmcnt(0)
ds_read_b128 v[224:227], v16 offset:13056
ds_read_b128 v[228:231], v16 offset:14144
ds_read_b128 v[232:235], v16 offset:15232
ds_read_b128 v[236:239], v16 offset:16320
s_waitcnt lgkmcnt(0)
buffer_store_dwordx4 v[224:227], v6, s[20:23], s34 offen offset:0 sc0 sc1
buffer_store_dwordx4 v[228:231], v7, s[20:23], s34 offen offset:1040 sc0 sc1
buffer_store_dwordx4 v[232:235], v8, s[20:23], s34 offen offset:2080 sc0 sc1
buffer_store_dwordx4 v[236:239], v9, s[20:23], s34 offen offset:3120 sc0 sc1
s_endpgm
.section .rodata,"a"
.p2align 6
.amdhsa_kernel standalone__gqa_softmax__near_ridge_kernel
  .amdhsa_next_free_vgpr 512
  .amdhsa_next_free_sgpr 102
  .amdhsa_accum_offset 256
  .amdhsa_group_segment_fixed_size 0
  .amdhsa_kernarg_size 48
  .amdhsa_user_sgpr_count 2
  .amdhsa_user_sgpr_kernarg_segment_ptr 1
  .amdhsa_system_sgpr_workgroup_id_x 1
.end_amdhsa_kernel
```
